```python
import torch

def _softmax(x, axis=-1):
    return torch.softmax(x, dim=axis)
def _gelu(x):
    return torch.nn.functional.gelu(x, approximate="tanh")
def _silu(x):
    return torch.nn.functional.silu(x)
def _sigmoid(x):
    return torch.sigmoid(x)
def _layernorm(x, axis=-1, eps=1e-5):
    m = x.mean(dim=axis, keepdim=True)
    v = x.var(dim=axis, keepdim=True, unbiased=False)
    return (x - m) / torch.sqrt(v + eps)
def _scatter_add(tgt, idx, src, axis=0):
    return tgt.clone().index_add_(axis, idx, src)
def _segment_sum(src, seg, n):
    out = torch.zeros((n,) + src.shape[1:], dtype=src.dtype)
    return out.index_add_(0, seg, src)
def _pad(x, pw):
    flat = tuple(v for pair in reversed(pw) for v in pair)
    return torch.nn.functional.pad(x, flat)

kernel_name = 'standalone__mha_block_cached__near_ridge'

def setup_inputs():

    _w = (lambda a: (lambda t: t.to(torch.bfloat16) if t.is_floating_point() else t)(torch.as_tensor(a)))
    B, Sq, D = 8, 224, 512
    H, Sk, Dh = 32, 1024, 128
    return {
        "x": _w((lambda *s: torch.randn(*s, dtype=torch.bfloat16) * 0.8)(B, Sq, D)),
        "k_cache": _w((lambda *s: torch.randn(*s, dtype=torch.bfloat16) * 0.8)(B, H, Sk, Dh)),
        "v_cache": _w((lambda *s: torch.randn(*s, dtype=torch.bfloat16) * 0.05)(B, H, Sk, Dh)),
        "wq": _w((lambda *s: torch.randn(*s, dtype=torch.bfloat16) * 0.8)(D, H * Dh) * (D ** -0.5)),
        "wo": _w((lambda *s: torch.randn(*s, dtype=torch.bfloat16) * 0.05)(H * Dh, D) * ((H * Dh) ** -0.5)),
    }

def reference(x, k_cache, v_cache, wq, wo):
    B, Sq, D = x.shape
    H, Dh = 32, 128
    q = (lambda x, *d: x.permute(*d))((x @ wq).reshape(B, Sq, H, Dh), 0, 2, 1, 3)
    scores = torch.einsum("bhqd,bhkd->bhqk", q, k_cache) * (Dh ** -0.5)
    p = _softmax(scores, axis=-1)
    o = torch.einsum("bhqk,bhkd->bhqd", p, v_cache)
    return (lambda x, *d: x.permute(*d))(o, 0, 2, 1, 3).reshape(B, Sq, H * Dh) @ wo
```

```asm
; @launch kernel=mha_attn_kernel grid=(256,1,1) block=(512,1,1) lds=163840
; @launch kernel=mha_oproj_kernel grid=(224,1,1) block=(512,1,1) lds=131072
.amdgcn_target "amdgcn-amd-amdhsa--gfx950"
.text
.globl mha_attn_kernel
.p2align 8
.type mha_attn_kernel,@function
mha_attn_kernel:
  s_cmp_ge_u32 s2, 256
  s_cbranch_scc1 K1_END
  s_load_dwordx16 s[32:47], s[0:1], 0
  s_and_b32 s48, s2, 7
  s_lshr_b32 s49, s2, 3
  s_and_b32 s50, s48, 1
  s_lshl_b32 s50, s50, 2
  s_and_b32 s51, s49, 3
  s_add_u32 s28, s50, s51
  s_lshr_b32 s50, s48, 1
  s_lshl_b32 s50, s50, 3
  s_lshr_b32 s51, s49, 2
  s_add_u32 s29, s50, s51
  v_lshrrev_b32 v1, 6, v0
  v_and_b32 v220, 63, v0
  s_nop 0
  v_readfirstlane_b32 s30, v1
  s_waitcnt lgkmcnt(0)
  s_mov_b32 s4, s32
  s_and_b32 s5, s33, 0xffff
  s_mov_b32 s6, 1835008
  s_mov_b32 s7, 0x20000
  s_lshl_b32 s48, s28, 5
  s_add_u32 s48, s48, s29
  s_lshl_b32 s49, s48, 18
  s_lshr_b32 s50, s48, 14
  s_add_u32 s34, s34, s49
  s_addc_u32 s35, s35, s50
  s_add_u32 s36, s36, s49
  s_addc_u32 s37, s37, s50
  s_mov_b32 s8, s34
  s_and_b32 s9, s35, 0xffff
  s_mov_b32 s10, 262144
  s_mov_b32 s11, 0x20000
  s_mov_b32 s12, s36
  s_and_b32 s13, s37, 0xffff
  s_mov_b32 s14, 262144
  s_mov_b32 s15, 0x20000
  s_mov_b32 s16, s38
  s_and_b32 s17, s39, 0xffff
  s_mov_b32 s18, 4194304
  s_mov_b32 s19, 0x20000
  s_mov_b32 s24, s40
  s_and_b32 s25, s41, 0xffff
  s_mov_b32 s26, 4194304
  s_mov_b32 s27, 0x20000
  s_mov_b32 s20, s46
  s_and_b32 s21, s47, 0xffff
  s_mov_b32 s22, 20971520
  s_mov_b32 s23, 0x20000
  s_cmp_eq_u32 s30, 7
  s_cbranch_scc1 K1_LOADER
  s_cmp_ge_u32 s30, 4
  s_cselect_b32 s53, 1, 0
  s_and_b32 s54, s30, 3
  s_lshl_b32 s54, s54, 12
  s_mul_i32 s52, s28, 224
  s_lshl_b32 s48, s30, 5
  s_add_u32 s52, s52, s48
  s_lshl_b32 s52, s52, 10
  v_lshrrev_b32 v225, 3, v220
  v_lshrrev_b32 v226, 4, v220
  v_and_b32 v227, 7, v220
  v_xor_b32 v227, v227, v226
  v_lshlrev_b32 v227, 4, v227
  v_lshl_add_u32 v214, v225, 10, v227
  v_xor_b32 v215, 64, v214
  v_lshrrev_b32 v225, 4, v220
  v_and_b32 v226, 15, v220
  v_lshlrev_b32 v227, 2, v225
  v_xor_b32 v227, v226, v227
  v_lshlrev_b32 v227, 4, v227
  v_lshl_add_u32 v228, v225, 13, v227
  s_lshl_b32 s48, s30, 11
  s_lshl_b32 s49, s30, 16
  s_lshl_b32 s50, s29, 8
  s_add_u32 s49, s49, s50
  s_add_u32 m0, s48, 32768
  s_add_u32 s50, s49, 0
  buffer_load_dwordx4 v228, s[16:19], s50 offen  lds
  s_add_u32 m0, s48, 33792
  s_add_u32 s50, s49, 32768
  buffer_load_dwordx4 v228, s[16:19], s50 offen  lds
  s_mul_i32 s48, s53, 16384
  s_add_u32 s48, s48, 0
  s_add_u32 s48, s48, s54
  s_add_u32 m0, s48, 0
  s_add_u32 s49, s52, 0
  buffer_load_dwordx4 v214, s[4:7], s49 offen  lds
  s_add_u32 m0, s48, 1024
  s_add_u32 s49, s52, 8192
  buffer_load_dwordx4 v215, s[4:7], s49 offen  lds
  s_add_u32 m0, s48, 2048
  s_add_u32 s49, s52, 16384
  buffer_load_dwordx4 v214, s[4:7], s49 offen  lds
  s_add_u32 m0, s48, 3072
  s_add_u32 s49, s52, 24576
  buffer_load_dwordx4 v215, s[4:7], s49 offen  lds
  v_and_b32 v225, 31, v220
  v_lshrrev_b32 v226, 5, v220
  v_bfe_u32 v227, v220, 1, 3
  v_xor_b32 v227, v227, v226
  v_lshlrev_b32 v227, 4, v227
  v_lshl_add_u32 v216, v225, 7, v227
  v_xor_b32 v217, 32, v216
  v_xor_b32 v218, 64, v216
  v_xor_b32 v219, 96, v216
  v_bfe_u32 v227, v220, 2, 2
  v_bfe_u32 v228, v220, 4, 1
  v_and_b32 v229, 1, v220
  v_bfe_u32 v230, v220, 1, 1
  v_lshlrev_b32 v231, 6, v227
  v_lshl_add_u32 v231, v228, 5, v231
  v_lshl_add_u32 v231, v229, 4, v231
  v_lshl_add_u32 v231, v230, 3, v231
  v_lshl_add_u32 v231, v227, 8, v231
  v_lshl_add_u32 v221, v226, 11, v231
  v_xor_b32 v222, 64, v221
  v_xor_b32 v223, 128, v221
  v_xor_b32 v224, 192, v221
  s_mov_b32 s60, 0x3e0293ee
  s_mov_b32 s61, s60
  s_mov_b32 s59, 0x53800000
  s_waitcnt vmcnt(0)
  s_mul_i32 s48, s53, 16384
  s_add_u32 s48, s48, 49152
  s_add_u32 s48, s48, s54
  s_add_u32 m0, s48, 0
  s_add_u32 s49, s52, 128
  buffer_load_dwordx4 v214, s[4:7], s49 offen  lds
  s_add_u32 m0, s48, 1024
  s_add_u32 s49, s52, 8320
  buffer_load_dwordx4 v215, s[4:7], s49 offen  lds
  s_add_u32 m0, s48, 2048
  s_add_u32 s49, s52, 16512
  buffer_load_dwordx4 v214, s[4:7], s49 offen  lds
  s_add_u32 m0, s48, 3072
  s_add_u32 s49, s52, 24704
  buffer_load_dwordx4 v215, s[4:7], s49 offen  lds
  s_mul_i32 s48, s53, 16384
  s_add_u32 s48, s48, 98304
  s_add_u32 s48, s48, s54
  s_add_u32 m0, s48, 0
  s_add_u32 s49, s52, 256
  buffer_load_dwordx4 v214, s[4:7], s49 offen  lds
  s_add_u32 m0, s48, 1024
  s_add_u32 s49, s52, 8448
  buffer_load_dwordx4 v215, s[4:7], s49 offen  lds
  s_add_u32 m0, s48, 2048
  s_add_u32 s49, s52, 16640
  buffer_load_dwordx4 v214, s[4:7], s49 offen  lds
  s_add_u32 m0, s48, 3072
  s_add_u32 s49, s52, 24832
  buffer_load_dwordx4 v215, s[4:7], s49 offen  lds
  s_barrier
  s_mul_i32 s48, s53, 16384
  s_add_u32 s48, s48, 0
  s_add_u32 s48, s48, s54
  v_add_u32 v192, s48, v216
  v_add_u32 v193, s48, v217
  v_add_u32 v194, s48, v218
  v_add_u32 v195, s48, v219
  v_add_u32 v200, 32768, v221
  v_add_u32 v201, 32768, v222
  v_add_u32 v202, 32768, v223
  v_add_u32 v203, 32768, v224
  ds_read_b128 v[144:147], v192
  ds_read_b64_tr_b16 v[160:161], v200 offset:0
  ds_read_b64_tr_b16 v[162:163], v200 offset:1024
  ds_read_b64_tr_b16 v[164:165], v201 offset:0
  ds_read_b64_tr_b16 v[166:167], v201 offset:1024
  ds_read_b64_tr_b16 v[168:169], v202 offset:0
  ds_read_b64_tr_b16 v[170:171], v202 offset:1024
  ds_read_b64_tr_b16 v[172:173], v203 offset:0
  ds_read_b64_tr_b16 v[174:175], v203 offset:1024
  s_waitcnt lgkmcnt(0)
  ds_read_b128 v[148:151], v193
  ds_read_b64_tr_b16 v[176:177], v200 offset:4096
  ds_read_b64_tr_b16 v[178:179], v200 offset:5120
  ds_read_b64_tr_b16 v[180:181], v201 offset:4096
  ds_read_b64_tr_b16 v[182:183], v201 offset:5120
  ds_read_b64_tr_b16 v[184:185], v202 offset:4096
  ds_read_b64_tr_b16 v[186:187], v202 offset:5120
  ds_read_b64_tr_b16 v[188:189], v203 offset:4096
  ds_read_b64_tr_b16 v[190:191], v203 offset:5120
  v_mfma_f32_32x32x16_bf16 v[64:79], v[160:163], v[144:147], 0
  v_mfma_f32_32x32x16_bf16 v[80:95], v[164:167], v[144:147], 0
  v_mfma_f32_32x32x16_bf16 v[96:111], v[168:171], v[144:147], 0
  v_mfma_f32_32x32x16_bf16 v[112:127], v[172:175], v[144:147], 0
  s_waitcnt lgkmcnt(0)
  ds_read_b128 v[144:147], v194
  ds_read_b64_tr_b16 v[160:161], v200 offset:8192
  ds_read_b64_tr_b16 v[162:163], v200 offset:9216
  ds_read_b64_tr_b16 v[164:165], v201 offset:8192
  ds_read_b64_tr_b16 v[166:167], v201 offset:9216
  ds_read_b64_tr_b16 v[168:169], v202 offset:8192
  ds_read_b64_tr_b16 v[170:171], v202 offset:9216
  ds_read_b64_tr_b16 v[172:173], v203 offset:8192
  ds_read_b64_tr_b16 v[174:175], v203 offset:9216
  v_mfma_f32_32x32x16_bf16 v[64:79], v[176:179], v[148:151], v[64:79]
  v_mfma_f32_32x32x16_bf16 v[80:95], v[180:183], v[148:151], v[80:95]
  v_mfma_f32_32x32x16_bf16 v[96:111], v[184:187], v[148:151], v[96:111]
  v_mfma_f32_32x32x16_bf16 v[112:127], v[188:191], v[148:151], v[112:127]
  s_waitcnt lgkmcnt(0)
  ds_read_b128 v[148:151], v195
  ds_read_b64_tr_b16 v[176:177], v200 offset:12288
  ds_read_b64_tr_b16 v[178:179], v200 offset:13312
  ds_read_b64_tr_b16 v[180:181], v201 offset:12288
  ds_read_b64_tr_b16 v[182:183], v201 offset:13312
  ds_read_b64_tr_b16 v[184:185], v202 offset:12288
  ds_read_b64_tr_b16 v[186:187], v202 offset:13312
  ds_read_b64_tr_b16 v[188:189], v203 offset:12288
  ds_read_b64_tr_b16 v[190:191], v203 offset:13312
  v_mfma_f32_32x32x16_bf16 v[64:79], v[160:163], v[144:147], v[64:79]
  v_mfma_f32_32x32x16_bf16 v[80:95], v[164:167], v[144:147], v[80:95]
  v_mfma_f32_32x32x16_bf16 v[96:111], v[168:171], v[144:147], v[96:111]
  v_mfma_f32_32x32x16_bf16 v[112:127], v[172:175], v[144:147], v[112:127]
  s_waitcnt lgkmcnt(0)
  s_waitcnt vmcnt(4)
  s_barrier
  s_mul_i32 s48, s53, -147456
  s_add_u32 s48, s48, 147456
  s_add_u32 s48, s48, s54
  s_add_u32 m0, s48, 0
  s_add_u32 s49, s52, 384
  buffer_load_dwordx4 v214, s[4:7], s49 offen  lds
  s_add_u32 m0, s48, 1024
  s_add_u32 s49, s52, 8576
  buffer_load_dwordx4 v215, s[4:7], s49 offen  lds
  s_add_u32 m0, s48, 2048
  s_add_u32 s49, s52, 16768
  buffer_load_dwordx4 v214, s[4:7], s49 offen  lds
  s_add_u32 m0, s48, 3072
  s_add_u32 s49, s52, 24960
  buffer_load_dwordx4 v215, s[4:7], s49 offen  lds
  s_mul_i32 s48, s53, 16384
  s_add_u32 s48, s48, 49152
  s_add_u32 s48, s48, s54
  v_add_u32 v192, s48, v216
  v_add_u32 v193, s48, v217
  v_add_u32 v194, s48, v218
  v_add_u32 v195, s48, v219
  v_add_u32 v200, 81920, v221
  v_add_u32 v201, 81920, v222
  v_add_u32 v202, 81920, v223
  v_add_u32 v203, 81920, v224
  ds_read_b128 v[144:147], v192
  ds_read_b64_tr_b16 v[160:161], v200 offset:0
  ds_read_b64_tr_b16 v[162:163], v200 offset:1024
  ds_read_b64_tr_b16 v[164:165], v201 offset:0
  ds_read_b64_tr_b16 v[166:167], v201 offset:1024
  ds_read_b64_tr_b16 v[168:169], v202 offset:0
  ds_read_b64_tr_b16 v[170:171], v202 offset:1024
  ds_read_b64_tr_b16 v[172:173], v203 offset:0
  ds_read_b64_tr_b16 v[174:175], v203 offset:1024
  v_mfma_f32_32x32x16_bf16 v[64:79], v[176:179], v[148:151], v[64:79]
  v_mfma_f32_32x32x16_bf16 v[80:95], v[180:183], v[148:151], v[80:95]
  v_mfma_f32_32x32x16_bf16 v[96:111], v[184:187], v[148:151], v[96:111]
  v_mfma_f32_32x32x16_bf16 v[112:127], v[188:191], v[148:151], v[112:127]
  s_waitcnt lgkmcnt(0)
  ds_read_b128 v[148:151], v193
  ds_read_b64_tr_b16 v[176:177], v200 offset:4096
  ds_read_b64_tr_b16 v[178:179], v200 offset:5120
  ds_read_b64_tr_b16 v[180:181], v201 offset:4096
  ds_read_b64_tr_b16 v[182:183], v201 offset:5120
  ds_read_b64_tr_b16 v[184:185], v202 offset:4096
  ds_read_b64_tr_b16 v[186:187], v202 offset:5120
  ds_read_b64_tr_b16 v[188:189], v203 offset:4096
  ds_read_b64_tr_b16 v[190:191], v203 offset:5120
  v_mfma_f32_32x32x16_bf16 v[64:79], v[160:163], v[144:147], v[64:79]
  v_mov_b32 v0, 0
  v_mfma_f32_32x32x16_bf16 v[80:95], v[164:167], v[144:147], v[80:95]
  v_mov_b32 v1, 0
  v_mfma_f32_32x32x16_bf16 v[96:111], v[168:171], v[144:147], v[96:111]
  v_mov_b32 v2, 0
  v_mfma_f32_32x32x16_bf16 v[112:127], v[172:175], v[144:147], v[112:127]
  v_mov_b32 v3, 0
  s_waitcnt lgkmcnt(0)
  ds_read_b128 v[144:147], v194
  ds_read_b64_tr_b16 v[160:161], v200 offset:8192
  ds_read_b64_tr_b16 v[162:163], v200 offset:9216
  ds_read_b64_tr_b16 v[164:165], v201 offset:8192
  ds_read_b64_tr_b16 v[166:167], v201 offset:9216
  ds_read_b64_tr_b16 v[168:169], v202 offset:8192
  ds_read_b64_tr_b16 v[170:171], v202 offset:9216
  ds_read_b64_tr_b16 v[172:173], v203 offset:8192
  ds_read_b64_tr_b16 v[174:175], v203 offset:9216
  v_mfma_f32_32x32x16_bf16 v[64:79], v[176:179], v[148:151], v[64:79]
  v_mov_b32 v4, 0
  v_mfma_f32_32x32x16_bf16 v[80:95], v[180:183], v[148:151], v[80:95]
  v_mov_b32 v5, 0
  v_mfma_f32_32x32x16_bf16 v[96:111], v[184:187], v[148:151], v[96:111]
  v_mov_b32 v6, 0
  v_mfma_f32_32x32x16_bf16 v[112:127], v[188:191], v[148:151], v[112:127]
  v_mov_b32 v7, 0
  s_waitcnt lgkmcnt(0)
  ds_read_b128 v[148:151], v195
  ds_read_b64_tr_b16 v[176:177], v200 offset:12288
  ds_read_b64_tr_b16 v[178:179], v200 offset:13312
  ds_read_b64_tr_b16 v[180:181], v201 offset:12288
  ds_read_b64_tr_b16 v[182:183], v201 offset:13312
  ds_read_b64_tr_b16 v[184:185], v202 offset:12288
  ds_read_b64_tr_b16 v[186:187], v202 offset:13312
  ds_read_b64_tr_b16 v[188:189], v203 offset:12288
  ds_read_b64_tr_b16 v[190:191], v203 offset:13312
  v_mfma_f32_32x32x16_bf16 v[64:79], v[160:163], v[144:147], v[64:79]
  v_mov_b32 v8, 0
  v_mfma_f32_32x32x16_bf16 v[80:95], v[164:167], v[144:147], v[80:95]
  v_mov_b32 v9, 0
  v_mfma_f32_32x32x16_bf16 v[96:111], v[168:171], v[144:147], v[96:111]
  v_mov_b32 v10, 0
  v_mfma_f32_32x32x16_bf16 v[112:127], v[172:175], v[144:147], v[112:127]
  v_mov_b32 v11, 0
  s_waitcnt lgkmcnt(0)
  s_waitcnt vmcnt(4)
  s_barrier
  s_mul_i32 s48, s53, 16384
  s_add_u32 s48, s48, 32768
  s_add_u32 s48, s48, s54
  s_add_u32 m0, s48, 0
  s_add_u32 s49, s52, 512
  buffer_load_dwordx4 v214, s[4:7], s49 offen  lds
  s_add_u32 m0, s48, 1024
  s_add_u32 s49, s52, 8704
  buffer_load_dwordx4 v215, s[4:7], s49 offen  lds
  s_add_u32 m0, s48, 2048
  s_add_u32 s49, s52, 16896
  buffer_load_dwordx4 v214, s[4:7], s49 offen  lds
  s_add_u32 m0, s48, 3072
  s_add_u32 s49, s52, 25088
  buffer_load_dwordx4 v215, s[4:7], s49 offen  lds
  s_mul_i32 s48, s53, 16384
  s_add_u32 s48, s48, 98304
  s_add_u32 s48, s48, s54
  v_add_u32 v192, s48, v216
  v_add_u32 v193, s48, v217
  v_add_u32 v194, s48, v218
  v_add_u32 v195, s48, v219
  v_add_u32 v200, 131072, v221
  v_add_u32 v201, 131072, v222
  v_add_u32 v202, 131072, v223
  v_add_u32 v203, 131072, v224
  ds_read_b128 v[144:147], v192
  ds_read_b64_tr_b16 v[160:161], v200 offset:0
  ds_read_b64_tr_b16 v[162:163], v200 offset:1024
  ds_read_b64_tr_b16 v[164:165], v201 offset:0
  ds_read_b64_tr_b16 v[166:167], v201 offset:1024
  ds_read_b64_tr_b16 v[168:169], v202 offset:0
  ds_read_b64_tr_b16 v[170:171], v202 offset:1024
  ds_read_b64_tr_b16 v[172:173], v203 offset:0
  ds_read_b64_tr_b16 v[174:175], v203 offset:1024
  v_mfma_f32_32x32x16_bf16 v[64:79], v[176:179], v[148:151], v[64:79]
  v_mov_b32 v12, 0
  v_mfma_f32_32x32x16_bf16 v[80:95], v[180:183], v[148:151], v[80:95]
  v_mov_b32 v13, 0
  v_mfma_f32_32x32x16_bf16 v[96:111], v[184:187], v[148:151], v[96:111]
  v_mov_b32 v14, 0
  v_mfma_f32_32x32x16_bf16 v[112:127], v[188:191], v[148:151], v[112:127]
  v_mov_b32 v15, 0
  s_waitcnt lgkmcnt(0)
  ds_read_b128 v[148:151], v193
  ds_read_b64_tr_b16 v[176:177], v200 offset:4096
  ds_read_b64_tr_b16 v[178:179], v200 offset:5120
  ds_read_b64_tr_b16 v[180:181], v201 offset:4096
  ds_read_b64_tr_b16 v[182:183], v201 offset:5120
  ds_read_b64_tr_b16 v[184:185], v202 offset:4096
  ds_read_b64_tr_b16 v[186:187], v202 offset:5120
  ds_read_b64_tr_b16 v[188:189], v203 offset:4096
  ds_read_b64_tr_b16 v[190:191], v203 offset:5120
  v_mfma_f32_32x32x16_bf16 v[64:79], v[160:163], v[144:147], v[64:79]
  v_mov_b32 v16, 0
  v_mfma_f32_32x32x16_bf16 v[80:95], v[164:167], v[144:147], v[80:95]
  v_mov_b32 v17, 0
  v_mfma_f32_32x32x16_bf16 v[96:111], v[168:171], v[144:147], v[96:111]
  v_mov_b32 v18, 0
  v_mfma_f32_32x32x16_bf16 v[112:127], v[172:175], v[144:147], v[112:127]
  v_mov_b32 v19, 0
  s_waitcnt lgkmcnt(0)
  ds_read_b128 v[144:147], v194
  ds_read_b64_tr_b16 v[160:161], v200 offset:8192
  ds_read_b64_tr_b16 v[162:163], v200 offset:9216
  ds_read_b64_tr_b16 v[164:165], v201 offset:8192
  ds_read_b64_tr_b16 v[166:167], v201 offset:9216
  ds_read_b64_tr_b16 v[168:169], v202 offset:8192
  ds_read_b64_tr_b16 v[170:171], v202 offset:9216
  ds_read_b64_tr_b16 v[172:173], v203 offset:8192
  ds_read_b64_tr_b16 v[174:175], v203 offset:9216
  v_mfma_f32_32x32x16_bf16 v[64:79], v[176:179], v[148:151], v[64:79]
  v_mov_b32 v20, 0
  v_mfma_f32_32x32x16_bf16 v[80:95], v[180:183], v[148:151], v[80:95]
  v_mov_b32 v21, 0
  v_mfma_f32_32x32x16_bf16 v[96:111], v[184:187], v[148:151], v[96:111]
  v_mov_b32 v22, 0
  v_mfma_f32_32x32x16_bf16 v[112:127], v[188:191], v[148:151], v[112:127]
  v_mov_b32 v23, 0
  s_waitcnt lgkmcnt(0)
  ds_read_b128 v[148:151], v195
  ds_read_b64_tr_b16 v[176:177], v200 offset:12288
  ds_read_b64_tr_b16 v[178:179], v200 offset:13312
  ds_read_b64_tr_b16 v[180:181], v201 offset:12288
  ds_read_b64_tr_b16 v[182:183], v201 offset:13312
  ds_read_b64_tr_b16 v[184:185], v202 offset:12288
  ds_read_b64_tr_b16 v[186:187], v202 offset:13312
  ds_read_b64_tr_b16 v[188:189], v203 offset:12288
  ds_read_b64_tr_b16 v[190:191], v203 offset:13312
  v_mfma_f32_32x32x16_bf16 v[64:79], v[160:163], v[144:147], v[64:79]
  v_mov_b32 v24, 0
  v_mfma_f32_32x32x16_bf16 v[80:95], v[164:167], v[144:147], v[80:95]
  v_mov_b32 v25, 0
  v_mfma_f32_32x32x16_bf16 v[96:111], v[168:171], v[144:147], v[96:111]
  v_mov_b32 v26, 0
  v_mfma_f32_32x32x16_bf16 v[112:127], v[172:175], v[144:147], v[112:127]
  v_mov_b32 v27, 0
  s_waitcnt lgkmcnt(0)
  s_waitcnt vmcnt(4)
  s_barrier
  s_mul_i32 s48, s53, 16384
  s_add_u32 s48, s48, 81920
  s_add_u32 s48, s48, s54
  s_add_u32 m0, s48, 0
  s_add_u32 s49, s52, 640
  buffer_load_dwordx4 v214, s[4:7], s49 offen  lds
  s_add_u32 m0, s48, 1024
  s_add_u32 s49, s52, 8832
  buffer_load_dwordx4 v215, s[4:7], s49 offen  lds
  s_add_u32 m0, s48, 2048
  s_add_u32 s49, s52, 17024
  buffer_load_dwordx4 v214, s[4:7], s49 offen  lds
  s_add_u32 m0, s48, 3072
  s_add_u32 s49, s52, 25216
  buffer_load_dwordx4 v215, s[4:7], s49 offen  lds
  s_mul_i32 s48, s53, -147456
  s_add_u32 s48, s48, 147456
  s_add_u32 s48, s48, s54
  v_add_u32 v192, s48, v216
  v_add_u32 v193, s48, v217
  v_add_u32 v194, s48, v218
  v_add_u32 v195, s48, v219
  v_add_u32 v200, 16384, v221
  v_add_u32 v201, 16384, v222
  v_add_u32 v202, 16384, v223
  v_add_u32 v203, 16384, v224
  ds_read_b128 v[144:147], v192
  ds_read_b64_tr_b16 v[160:161], v200 offset:0
  ds_read_b64_tr_b16 v[162:163], v200 offset:1024
  ds_read_b64_tr_b16 v[164:165], v201 offset:0
  ds_read_b64_tr_b16 v[166:167], v201 offset:1024
  ds_read_b64_tr_b16 v[168:169], v202 offset:0
  ds_read_b64_tr_b16 v[170:171], v202 offset:1024
  ds_read_b64_tr_b16 v[172:173], v203 offset:0
  ds_read_b64_tr_b16 v[174:175], v203 offset:1024
  v_mfma_f32_32x32x16_bf16 v[64:79], v[176:179], v[148:151], v[64:79]
  v_mov_b32 v28, 0
  v_mfma_f32_32x32x16_bf16 v[80:95], v[180:183], v[148:151], v[80:95]
  v_mov_b32 v29, 0
  v_mfma_f32_32x32x16_bf16 v[96:111], v[184:187], v[148:151], v[96:111]
  v_mov_b32 v30, 0
  v_mfma_f32_32x32x16_bf16 v[112:127], v[188:191], v[148:151], v[112:127]
  v_mov_b32 v31, 0
  s_waitcnt lgkmcnt(0)
  ds_read_b128 v[148:151], v193
  ds_read_b64_tr_b16 v[176:177], v200 offset:4096
  ds_read_b64_tr_b16 v[178:179], v200 offset:5120
  ds_read_b64_tr_b16 v[180:181], v201 offset:4096
  ds_read_b64_tr_b16 v[182:183], v201 offset:5120
  ds_read_b64_tr_b16 v[184:185], v202 offset:4096
  ds_read_b64_tr_b16 v[186:187], v202 offset:5120
  ds_read_b64_tr_b16 v[188:189], v203 offset:4096
  ds_read_b64_tr_b16 v[190:191], v203 offset:5120
  v_mfma_f32_32x32x16_bf16 v[64:79], v[160:163], v[144:147], v[64:79]
  v_mov_b32 v32, 0
  v_mfma_f32_32x32x16_bf16 v[80:95], v[164:167], v[144:147], v[80:95]
  v_mov_b32 v33, 0
  v_mfma_f32_32x32x16_bf16 v[96:111], v[168:171], v[144:147], v[96:111]
  v_mov_b32 v34, 0
  v_mfma_f32_32x32x16_bf16 v[112:127], v[172:175], v[144:147], v[112:127]
  v_mov_b32 v35, 0
  s_waitcnt lgkmcnt(0)
  ds_read_b128 v[144:147], v194
  ds_read_b64_tr_b16 v[160:161], v200 offset:8192
  ds_read_b64_tr_b16 v[162:163], v200 offset:9216
  ds_read_b64_tr_b16 v[164:165], v201 offset:8192
  ds_read_b64_tr_b16 v[166:167], v201 offset:9216
  ds_read_b64_tr_b16 v[168:169], v202 offset:8192
  ds_read_b64_tr_b16 v[170:171], v202 offset:9216
  ds_read_b64_tr_b16 v[172:173], v203 offset:8192
  ds_read_b64_tr_b16 v[174:175], v203 offset:9216
  v_mfma_f32_32x32x16_bf16 v[64:79], v[176:179], v[148:151], v[64:79]
  v_mov_b32 v36, 0
  v_mfma_f32_32x32x16_bf16 v[80:95], v[180:183], v[148:151], v[80:95]
  v_mov_b32 v37, 0
  v_mfma_f32_32x32x16_bf16 v[96:111], v[184:187], v[148:151], v[96:111]
  v_mov_b32 v38, 0
  v_mfma_f32_32x32x16_bf16 v[112:127], v[188:191], v[148:151], v[112:127]
  v_mov_b32 v39, 0
  s_waitcnt lgkmcnt(0)
  ds_read_b128 v[148:151], v195
  ds_read_b64_tr_b16 v[176:177], v200 offset:12288
  ds_read_b64_tr_b16 v[178:179], v200 offset:13312
  ds_read_b64_tr_b16 v[180:181], v201 offset:12288
  ds_read_b64_tr_b16 v[182:183], v201 offset:13312
  ds_read_b64_tr_b16 v[184:185], v202 offset:12288
  ds_read_b64_tr_b16 v[186:187], v202 offset:13312
  ds_read_b64_tr_b16 v[188:189], v203 offset:12288
  ds_read_b64_tr_b16 v[190:191], v203 offset:13312
  v_mfma_f32_32x32x16_bf16 v[64:79], v[160:163], v[144:147], v[64:79]
  v_mov_b32 v40, 0
  v_mfma_f32_32x32x16_bf16 v[80:95], v[164:167], v[144:147], v[80:95]
  v_mov_b32 v41, 0
  v_mfma_f32_32x32x16_bf16 v[96:111], v[168:171], v[144:147], v[96:111]
  v_mov_b32 v42, 0
  v_mfma_f32_32x32x16_bf16 v[112:127], v[172:175], v[144:147], v[112:127]
  v_mov_b32 v43, 0
  s_waitcnt lgkmcnt(0)
  s_waitcnt vmcnt(4)
  s_barrier
  s_mul_i32 s48, s53, 16384
  s_add_u32 s48, s48, 131072
  s_add_u32 s48, s48, s54
  s_add_u32 m0, s48, 0
  s_add_u32 s49, s52, 768
  buffer_load_dwordx4 v214, s[4:7], s49 offen  lds
  s_add_u32 m0, s48, 1024
  s_add_u32 s49, s52, 8960
  buffer_load_dwordx4 v215, s[4:7], s49 offen  lds
  s_add_u32 m0, s48, 2048
  s_add_u32 s49, s52, 17152
  buffer_load_dwordx4 v214, s[4:7], s49 offen  lds
  s_add_u32 m0, s48, 3072
  s_add_u32 s49, s52, 25344
  buffer_load_dwordx4 v215, s[4:7], s49 offen  lds
  s_mul_i32 s48, s53, 16384
  s_add_u32 s48, s48, 32768
  s_add_u32 s48, s48, s54
  v_add_u32 v192, s48, v216
  v_add_u32 v193, s48, v217
  v_add_u32 v194, s48, v218
  v_add_u32 v195, s48, v219
  v_add_u32 v200, 65536, v221
  v_add_u32 v201, 65536, v222
  v_add_u32 v202, 65536, v223
  v_add_u32 v203, 65536, v224
  ds_read_b128 v[144:147], v192
  ds_read_b64_tr_b16 v[160:161], v200 offset:0
  ds_read_b64_tr_b16 v[162:163], v200 offset:1024
  ds_read_b64_tr_b16 v[164:165], v201 offset:0
  ds_read_b64_tr_b16 v[166:167], v201 offset:1024
  ds_read_b64_tr_b16 v[168:169], v202 offset:0
  ds_read_b64_tr_b16 v[170:171], v202 offset:1024
  ds_read_b64_tr_b16 v[172:173], v203 offset:0
  ds_read_b64_tr_b16 v[174:175], v203 offset:1024
  v_mfma_f32_32x32x16_bf16 v[64:79], v[176:179], v[148:151], v[64:79]
  v_mov_b32 v44, 0
  v_mfma_f32_32x32x16_bf16 v[80:95], v[180:183], v[148:151], v[80:95]
  v_mov_b32 v45, 0
  v_mfma_f32_32x32x16_bf16 v[96:111], v[184:187], v[148:151], v[96:111]
  v_mov_b32 v46, 0
  v_mfma_f32_32x32x16_bf16 v[112:127], v[188:191], v[148:151], v[112:127]
  v_mov_b32 v47, 0
  s_waitcnt lgkmcnt(0)
  ds_read_b128 v[148:151], v193
  ds_read_b64_tr_b16 v[176:177], v200 offset:4096
  ds_read_b64_tr_b16 v[178:179], v200 offset:5120
  ds_read_b64_tr_b16 v[180:181], v201 offset:4096
  ds_read_b64_tr_b16 v[182:183], v201 offset:5120
  ds_read_b64_tr_b16 v[184:185], v202 offset:4096
  ds_read_b64_tr_b16 v[186:187], v202 offset:5120
  ds_read_b64_tr_b16 v[188:189], v203 offset:4096
  ds_read_b64_tr_b16 v[190:191], v203 offset:5120
  v_mfma_f32_32x32x16_bf16 v[64:79], v[160:163], v[144:147], v[64:79]
  v_mov_b32 v48, 0
  v_mfma_f32_32x32x16_bf16 v[80:95], v[164:167], v[144:147], v[80:95]
  v_mov_b32 v49, 0
  v_mfma_f32_32x32x16_bf16 v[96:111], v[168:171], v[144:147], v[96:111]
  v_mov_b32 v50, 0
  v_mfma_f32_32x32x16_bf16 v[112:127], v[172:175], v[144:147], v[112:127]
  v_mov_b32 v51, 0
  s_waitcnt lgkmcnt(0)
  ds_read_b128 v[144:147], v194
  ds_read_b64_tr_b16 v[160:161], v200 offset:8192
  ds_read_b64_tr_b16 v[162:163], v200 offset:9216
  ds_read_b64_tr_b16 v[164:165], v201 offset:8192
  ds_read_b64_tr_b16 v[166:167], v201 offset:9216
  ds_read_b64_tr_b16 v[168:169], v202 offset:8192
  ds_read_b64_tr_b16 v[170:171], v202 offset:9216
  ds_read_b64_tr_b16 v[172:173], v203 offset:8192
  ds_read_b64_tr_b16 v[174:175], v203 offset:9216
  v_mfma_f32_32x32x16_bf16 v[64:79], v[176:179], v[148:151], v[64:79]
  v_mov_b32 v52, 0
  v_mfma_f32_32x32x16_bf16 v[80:95], v[180:183], v[148:151], v[80:95]
  v_mov_b32 v53, 0
  v_mfma_f32_32x32x16_bf16 v[96:111], v[184:187], v[148:151], v[96:111]
  v_mov_b32 v54, 0
  v_mfma_f32_32x32x16_bf16 v[112:127], v[188:191], v[148:151], v[112:127]
  v_mov_b32 v55, 0
  s_waitcnt lgkmcnt(0)
  ds_read_b128 v[148:151], v195
  ds_read_b64_tr_b16 v[176:177], v200 offset:12288
  ds_read_b64_tr_b16 v[178:179], v200 offset:13312
  ds_read_b64_tr_b16 v[180:181], v201 offset:12288
  ds_read_b64_tr_b16 v[182:183], v201 offset:13312
  ds_read_b64_tr_b16 v[184:185], v202 offset:12288
  ds_read_b64_tr_b16 v[186:187], v202 offset:13312
  ds_read_b64_tr_b16 v[188:189], v203 offset:12288
  ds_read_b64_tr_b16 v[190:191], v203 offset:13312
  v_mfma_f32_32x32x16_bf16 v[64:79], v[160:163], v[144:147], v[64:79]
  v_mov_b32 v56, 0
  v_mfma_f32_32x32x16_bf16 v[80:95], v[164:167], v[144:147], v[80:95]
  v_mov_b32 v57, 0
  v_mfma_f32_32x32x16_bf16 v[96:111], v[168:171], v[144:147], v[96:111]
  v_mov_b32 v58, 0
  v_mfma_f32_32x32x16_bf16 v[112:127], v[172:175], v[144:147], v[112:127]
  v_mov_b32 v59, 0
  s_waitcnt lgkmcnt(0)
  s_waitcnt vmcnt(4)
  s_barrier
  s_mul_i32 s48, s53, 16384
  s_add_u32 s48, s48, 16384
  s_add_u32 s48, s48, s54
  s_add_u32 m0, s48, 0
  s_add_u32 s49, s52, 896
  buffer_load_dwordx4 v214, s[4:7], s49 offen  lds
  s_add_u32 m0, s48, 1024
  s_add_u32 s49, s52, 9088
  buffer_load_dwordx4 v215, s[4:7], s49 offen  lds
  s_add_u32 m0, s48, 2048
  s_add_u32 s49, s52, 17280
  buffer_load_dwordx4 v214, s[4:7], s49 offen  lds
  s_add_u32 m0, s48, 3072
  s_add_u32 s49, s52, 25472
  buffer_load_dwordx4 v215, s[4:7], s49 offen  lds
  s_mul_i32 s48, s53, 16384
  s_add_u32 s48, s48, 81920
  s_add_u32 s48, s48, s54
  v_add_u32 v192, s48, v216
  v_add_u32 v193, s48, v217
  v_add_u32 v194, s48, v218
  v_add_u32 v195, s48, v219
  v_add_u32 v200, 114688, v221
  v_add_u32 v201, 114688, v222
  v_add_u32 v202, 114688, v223
  v_add_u32 v203, 114688, v224
  ds_read_b128 v[144:147], v192
  ds_read_b64_tr_b16 v[160:161], v200 offset:0
  ds_read_b64_tr_b16 v[162:163], v200 offset:1024
  ds_read_b64_tr_b16 v[164:165], v201 offset:0
  ds_read_b64_tr_b16 v[166:167], v201 offset:1024
  ds_read_b64_tr_b16 v[168:169], v202 offset:0
  ds_read_b64_tr_b16 v[170:171], v202 offset:1024
  ds_read_b64_tr_b16 v[172:173], v203 offset:0
  ds_read_b64_tr_b16 v[174:175], v203 offset:1024
  v_mfma_f32_32x32x16_bf16 v[64:79], v[176:179], v[148:151], v[64:79]
  v_mov_b32 v60, 0
  v_mfma_f32_32x32x16_bf16 v[80:95], v[180:183], v[148:151], v[80:95]
  v_mov_b32 v61, 0
  v_mfma_f32_32x32x16_bf16 v[96:111], v[184:187], v[148:151], v[96:111]
  v_mov_b32 v62, 0
  v_mfma_f32_32x32x16_bf16 v[112:127], v[188:191], v[148:151], v[112:127]
  v_mov_b32 v63, 0
  s_waitcnt lgkmcnt(0)
  ds_read_b128 v[148:151], v193
  ds_read_b64_tr_b16 v[176:177], v200 offset:4096
  ds_read_b64_tr_b16 v[178:179], v200 offset:5120
  ds_read_b64_tr_b16 v[180:181], v201 offset:4096
  ds_read_b64_tr_b16 v[182:183], v201 offset:5120
  ds_read_b64_tr_b16 v[184:185], v202 offset:4096
  ds_read_b64_tr_b16 v[186:187], v202 offset:5120
  ds_read_b64_tr_b16 v[188:189], v203 offset:4096
  ds_read_b64_tr_b16 v[190:191], v203 offset:5120
  v_mfma_f32_32x32x16_bf16 v[64:79], v[160:163], v[144:147], v[64:79]
  v_mfma_f32_32x32x16_bf16 v[80:95], v[164:167], v[144:147], v[80:95]
  v_mfma_f32_32x32x16_bf16 v[96:111], v[168:171], v[144:147], v[96:111]
  v_mfma_f32_32x32x16_bf16 v[112:127], v[172:175], v[144:147], v[112:127]
  s_waitcnt lgkmcnt(0)
  ds_read_b128 v[144:147], v194
  ds_read_b64_tr_b16 v[160:161], v200 offset:8192
  ds_read_b64_tr_b16 v[162:163], v200 offset:9216
  ds_read_b64_tr_b16 v[164:165], v201 offset:8192
  ds_read_b64_tr_b16 v[166:167], v201 offset:9216
  ds_read_b64_tr_b16 v[168:169], v202 offset:8192
  ds_read_b64_tr_b16 v[170:171], v202 offset:9216
  ds_read_b64_tr_b16 v[172:173], v203 offset:8192
  ds_read_b64_tr_b16 v[174:175], v203 offset:9216
  v_mfma_f32_32x32x16_bf16 v[64:79], v[176:179], v[148:151], v[64:79]
  v_mfma_f32_32x32x16_bf16 v[80:95], v[180:183], v[148:151], v[80:95]
  v_mfma_f32_32x32x16_bf16 v[96:111], v[184:187], v[148:151], v[96:111]
  v_mfma_f32_32x32x16_bf16 v[112:127], v[188:191], v[148:151], v[112:127]
  s_waitcnt lgkmcnt(0)
  ds_read_b128 v[148:151], v195
  ds_read_b64_tr_b16 v[176:177], v200 offset:12288
  ds_read_b64_tr_b16 v[178:179], v200 offset:13312
  ds_read_b64_tr_b16 v[180:181], v201 offset:12288
  ds_read_b64_tr_b16 v[182:183], v201 offset:13312
  ds_read_b64_tr_b16 v[184:185], v202 offset:12288
  ds_read_b64_tr_b16 v[186:187], v202 offset:13312
  ds_read_b64_tr_b16 v[188:189], v203 offset:12288
  ds_read_b64_tr_b16 v[190:191], v203 offset:13312
  v_mfma_f32_32x32x16_bf16 v[64:79], v[160:163], v[144:147], v[64:79]
  v_mfma_f32_32x32x16_bf16 v[80:95], v[164:167], v[144:147], v[80:95]
  v_mfma_f32_32x32x16_bf16 v[96:111], v[168:171], v[144:147], v[96:111]
  v_mfma_f32_32x32x16_bf16 v[112:127], v[172:175], v[144:147], v[112:127]
  s_waitcnt lgkmcnt(0)
  s_waitcnt vmcnt(4)
  s_barrier
  s_mul_i32 s48, s53, 16384
  s_add_u32 s48, s48, 131072
  s_add_u32 s48, s48, s54
  v_add_u32 v192, s48, v216
  v_add_u32 v193, s48, v217
  v_add_u32 v194, s48, v218
  v_add_u32 v195, s48, v219
  v_add_u32 v200, 0, v221
  v_add_u32 v201, 0, v222
  v_add_u32 v202, 0, v223
  v_add_u32 v203, 0, v224
  ds_read_b128 v[144:147], v192
  ds_read_b64_tr_b16 v[160:161], v200 offset:0
  ds_read_b64_tr_b16 v[162:163], v200 offset:1024
  ds_read_b64_tr_b16 v[164:165], v201 offset:0
  ds_read_b64_tr_b16 v[166:167], v201 offset:1024
  ds_read_b64_tr_b16 v[168:169], v202 offset:0
  ds_read_b64_tr_b16 v[170:171], v202 offset:1024
  ds_read_b64_tr_b16 v[172:173], v203 offset:0
  ds_read_b64_tr_b16 v[174:175], v203 offset:1024
  v_mfma_f32_32x32x16_bf16 v[64:79], v[176:179], v[148:151], v[64:79]
  v_mfma_f32_32x32x16_bf16 v[80:95], v[180:183], v[148:151], v[80:95]
  v_mfma_f32_32x32x16_bf16 v[96:111], v[184:187], v[148:151], v[96:111]
  v_mfma_f32_32x32x16_bf16 v[112:127], v[188:191], v[148:151], v[112:127]
  s_waitcnt lgkmcnt(0)
  ds_read_b128 v[148:151], v193
  ds_read_b64_tr_b16 v[176:177], v200 offset:4096
  ds_read_b64_tr_b16 v[178:179], v200 offset:5120
  ds_read_b64_tr_b16 v[180:181], v201 offset:4096
  ds_read_b64_tr_b16 v[182:183], v201 offset:5120
  ds_read_b64_tr_b16 v[184:185], v202 offset:4096
  ds_read_b64_tr_b16 v[186:187], v202 offset:5120
  ds_read_b64_tr_b16 v[188:189], v203 offset:4096
  ds_read_b64_tr_b16 v[190:191], v203 offset:5120
  v_mfma_f32_32x32x16_bf16 v[64:79], v[160:163], v[144:147], v[64:79]
  v_mfma_f32_32x32x16_bf16 v[80:95], v[164:167], v[144:147], v[80:95]
  v_mfma_f32_32x32x16_bf16 v[96:111], v[168:171], v[144:147], v[96:111]
  v_mfma_f32_32x32x16_bf16 v[112:127], v[172:175], v[144:147], v[112:127]
  s_waitcnt lgkmcnt(0)
  ds_read_b128 v[144:147], v194
  ds_read_b64_tr_b16 v[160:161], v200 offset:8192
  ds_read_b64_tr_b16 v[162:163], v200 offset:9216
  ds_read_b64_tr_b16 v[164:165], v201 offset:8192
  ds_read_b64_tr_b16 v[166:167], v201 offset:9216
  ds_read_b64_tr_b16 v[168:169], v202 offset:8192
  ds_read_b64_tr_b16 v[170:171], v202 offset:9216
  ds_read_b64_tr_b16 v[172:173], v203 offset:8192
  ds_read_b64_tr_b16 v[174:175], v203 offset:9216
  v_mfma_f32_32x32x16_bf16 v[64:79], v[176:179], v[148:151], v[64:79]
  v_mfma_f32_32x32x16_bf16 v[80:95], v[180:183], v[148:151], v[80:95]
  v_mfma_f32_32x32x16_bf16 v[96:111], v[184:187], v[148:151], v[96:111]
  v_mfma_f32_32x32x16_bf16 v[112:127], v[188:191], v[148:151], v[112:127]
  s_waitcnt lgkmcnt(0)
  ds_read_b128 v[148:151], v195
  ds_read_b64_tr_b16 v[176:177], v200 offset:12288
  ds_read_b64_tr_b16 v[178:179], v200 offset:13312
  ds_read_b64_tr_b16 v[180:181], v201 offset:12288
  ds_read_b64_tr_b16 v[182:183], v201 offset:13312
  ds_read_b64_tr_b16 v[184:185], v202 offset:12288
  ds_read_b64_tr_b16 v[186:187], v202 offset:13312
  ds_read_b64_tr_b16 v[188:189], v203 offset:12288
  ds_read_b64_tr_b16 v[190:191], v203 offset:13312
  v_mfma_f32_32x32x16_bf16 v[64:79], v[160:163], v[144:147], v[64:79]
  v_mfma_f32_32x32x16_bf16 v[80:95], v[164:167], v[144:147], v[80:95]
  v_mfma_f32_32x32x16_bf16 v[96:111], v[168:171], v[144:147], v[96:111]
  v_mfma_f32_32x32x16_bf16 v[112:127], v[172:175], v[144:147], v[112:127]
  s_waitcnt lgkmcnt(0)
  s_waitcnt vmcnt(0)
  s_barrier
  s_mul_i32 s48, s53, 16384
  s_add_u32 s48, s48, 16384
  s_add_u32 s48, s48, s54
  v_add_u32 v192, s48, v216
  v_add_u32 v193, s48, v217
  v_add_u32 v194, s48, v218
  v_add_u32 v195, s48, v219
  v_add_u32 v200, 49152, v221
  v_add_u32 v201, 49152, v222
  v_add_u32 v202, 49152, v223
  v_add_u32 v203, 49152, v224
  ds_read_b128 v[144:147], v192
  ds_read_b64_tr_b16 v[160:161], v200 offset:0
  ds_read_b64_tr_b16 v[162:163], v200 offset:1024
  ds_read_b64_tr_b16 v[164:165], v201 offset:0
  ds_read_b64_tr_b16 v[166:167], v201 offset:1024
  ds_read_b64_tr_b16 v[168:169], v202 offset:0
  ds_read_b64_tr_b16 v[170:171], v202 offset:1024
  ds_read_b64_tr_b16 v[172:173], v203 offset:0
  ds_read_b64_tr_b16 v[174:175], v203 offset:1024
  v_mfma_f32_32x32x16_bf16 v[64:79], v[176:179], v[148:151], v[64:79]
  v_mfma_f32_32x32x16_bf16 v[80:95], v[180:183], v[148:151], v[80:95]
  v_mfma_f32_32x32x16_bf16 v[96:111], v[184:187], v[148:151], v[96:111]
  v_mfma_f32_32x32x16_bf16 v[112:127], v[188:191], v[148:151], v[112:127]
  s_waitcnt lgkmcnt(0)
  ds_read_b128 v[148:151], v193
  ds_read_b64_tr_b16 v[176:177], v200 offset:4096
  ds_read_b64_tr_b16 v[178:179], v200 offset:5120
  ds_read_b64_tr_b16 v[180:181], v201 offset:4096
  ds_read_b64_tr_b16 v[182:183], v201 offset:5120
  ds_read_b64_tr_b16 v[184:185], v202 offset:4096
  ds_read_b64_tr_b16 v[186:187], v202 offset:5120
  ds_read_b64_tr_b16 v[188:189], v203 offset:4096
  ds_read_b64_tr_b16 v[190:191], v203 offset:5120
  v_mfma_f32_32x32x16_bf16 v[64:79], v[160:163], v[144:147], v[64:79]
  v_mfma_f32_32x32x16_bf16 v[80:95], v[164:167], v[144:147], v[80:95]
  v_mfma_f32_32x32x16_bf16 v[96:111], v[168:171], v[144:147], v[96:111]
  v_mfma_f32_32x32x16_bf16 v[112:127], v[172:175], v[144:147], v[112:127]
  s_waitcnt lgkmcnt(0)
  ds_read_b128 v[144:147], v194
  ds_read_b64_tr_b16 v[160:161], v200 offset:8192
  ds_read_b64_tr_b16 v[162:163], v200 offset:9216
  ds_read_b64_tr_b16 v[164:165], v201 offset:8192
  ds_read_b64_tr_b16 v[166:167], v201 offset:9216
  ds_read_b64_tr_b16 v[168:169], v202 offset:8192
  ds_read_b64_tr_b16 v[170:171], v202 offset:9216
  ds_read_b64_tr_b16 v[172:173], v203 offset:8192
  ds_read_b64_tr_b16 v[174:175], v203 offset:9216
  v_mfma_f32_32x32x16_bf16 v[64:79], v[176:179], v[148:151], v[64:79]
  v_mfma_f32_32x32x16_bf16 v[80:95], v[180:183], v[148:151], v[80:95]
  v_mfma_f32_32x32x16_bf16 v[96:111], v[184:187], v[148:151], v[96:111]
  v_mfma_f32_32x32x16_bf16 v[112:127], v[188:191], v[148:151], v[112:127]
  s_waitcnt lgkmcnt(0)
  ds_read_b128 v[148:151], v195
  ds_read_b64_tr_b16 v[176:177], v200 offset:12288
  ds_read_b64_tr_b16 v[178:179], v200 offset:13312
  ds_read_b64_tr_b16 v[180:181], v201 offset:12288
  ds_read_b64_tr_b16 v[182:183], v201 offset:13312
  ds_read_b64_tr_b16 v[184:185], v202 offset:12288
  ds_read_b64_tr_b16 v[186:187], v202 offset:13312
  ds_read_b64_tr_b16 v[188:189], v203 offset:12288
  ds_read_b64_tr_b16 v[190:191], v203 offset:13312
  v_mfma_f32_32x32x16_bf16 v[64:79], v[160:163], v[144:147], v[64:79]
  v_mfma_f32_32x32x16_bf16 v[80:95], v[164:167], v[144:147], v[80:95]
  v_mfma_f32_32x32x16_bf16 v[96:111], v[168:171], v[144:147], v[96:111]
  v_mfma_f32_32x32x16_bf16 v[112:127], v[172:175], v[144:147], v[112:127]
  s_waitcnt lgkmcnt(0)
  v_mfma_f32_32x32x16_bf16 v[64:79], v[176:179], v[148:151], v[64:79]
  v_mfma_f32_32x32x16_bf16 v[80:95], v[180:183], v[148:151], v[80:95]
  v_mfma_f32_32x32x16_bf16 v[96:111], v[184:187], v[148:151], v[96:111]
  v_mfma_f32_32x32x16_bf16 v[112:127], v[188:191], v[148:151], v[112:127]
  v_and_b32 v227, 15, v220
  v_xor_b32 v227, v227, v226
  v_lshlrev_b32 v227, 4, v227
  v_lshl_add_u32 v227, v225, 8, v227
  v_add_u32 v192, 65536, v227
  v_xor_b32 v193, 32, v192
  v_xor_b32 v194, 64, v192
  v_xor_b32 v195, 96, v192
  v_xor_b32 v196, 128, v192
  v_xor_b32 v197, 160, v192
  v_xor_b32 v198, 192, v192
  v_xor_b32 v199, 224, v192
  v_lshl_add_u32 v228, v226, 10, v231
  v_add_u32 v200, 65536, v228
  v_xor_b32 v201, 64, v200
  v_xor_b32 v202, 128, v200
  v_xor_b32 v203, 192, v200
  s_mov_b32 s55, 65536
  s_barrier
  ds_read_b128 v[160:163], v192 offset:16384
  ds_read_b128 v[164:167], v193 offset:16384
  ds_read_b128 v[168:171], v194 offset:16384
  ds_read_b128 v[172:175], v195 offset:16384
  ds_read_b128 v[176:179], v196 offset:16384
  ds_read_b128 v[180:183], v197 offset:16384
  ds_read_b128 v[184:187], v198 offset:16384
  ds_read_b128 v[188:191], v199 offset:16384
  s_nop 4
  v_pk_mul_f32 v[112:113], v[112:113], s[60:61]
  v_pk_mul_f32 v[114:115], v[114:115], s[60:61]
  v_pk_mul_f32 v[116:117], v[116:117], s[60:61]
  v_pk_mul_f32 v[118:119], v[118:119], s[60:61]
  v_cvt_pk_bf16_f32 v136, v112, v113
  v_cvt_pk_bf16_f32 v137, v114, v115
  v_cvt_pk_bf16_f32 v138, v116, v117
  v_cvt_pk_bf16_f32 v139, v118, v119
  v_pk_mul_f32 v[120:121], v[120:121], s[60:61]
  v_pk_mul_f32 v[122:123], v[122:123], s[60:61]
  v_pk_mul_f32 v[124:125], v[124:125], s[60:61]
  v_pk_mul_f32 v[126:127], v[126:127], s[60:61]
  v_cvt_pk_bf16_f32 v140, v120, v121
  v_cvt_pk_bf16_f32 v141, v122, v123
  v_cvt_pk_bf16_f32 v142, v124, v125
  v_cvt_pk_bf16_f32 v143, v126, v127
  v_pk_mul_f32 v[96:97], v[96:97], s[60:61]
  v_pk_mul_f32 v[98:99], v[98:99], s[60:61]
  v_pk_mul_f32 v[100:101], v[100:101], s[60:61]
  v_pk_mul_f32 v[102:103], v[102:103], s[60:61]
  v_cvt_pk_bf16_f32 v128, v96, v97
  v_cvt_pk_bf16_f32 v129, v98, v99
  v_cvt_pk_bf16_f32 v130, v100, v101
  v_cvt_pk_bf16_f32 v131, v102, v103
  v_pk_mul_f32 v[104:105], v[104:105], s[60:61]
  v_pk_mul_f32 v[106:107], v[106:107], s[60:61]
  v_pk_mul_f32 v[108:109], v[108:109], s[60:61]
  v_pk_mul_f32 v[110:111], v[110:111], s[60:61]
  v_cvt_pk_bf16_f32 v132, v104, v105
  v_cvt_pk_bf16_f32 v133, v106, v107
  v_cvt_pk_bf16_f32 v134, v108, v109
  v_cvt_pk_bf16_f32 v135, v110, v111
  v_pk_mul_f32 v[80:81], v[80:81], s[60:61]
  v_pk_mul_f32 v[82:83], v[82:83], s[60:61]
  v_pk_mul_f32 v[84:85], v[84:85], s[60:61]
  v_pk_mul_f32 v[86:87], v[86:87], s[60:61]
  v_cvt_pk_bf16_f32 v120, v80, v81
  v_cvt_pk_bf16_f32 v121, v82, v83
  v_cvt_pk_bf16_f32 v122, v84, v85
  v_cvt_pk_bf16_f32 v123, v86, v87
  v_pk_mul_f32 v[88:89], v[88:89], s[60:61]
  v_pk_mul_f32 v[90:91], v[90:91], s[60:61]
  v_pk_mul_f32 v[92:93], v[92:93], s[60:61]
  v_pk_mul_f32 v[94:95], v[94:95], s[60:61]
  v_cvt_pk_bf16_f32 v124, v88, v89
  v_cvt_pk_bf16_f32 v125, v90, v91
  v_cvt_pk_bf16_f32 v126, v92, v93
  v_cvt_pk_bf16_f32 v127, v94, v95
  v_pk_mul_f32 v[64:65], v[64:65], s[60:61]
  v_pk_mul_f32 v[66:67], v[66:67], s[60:61]
  v_pk_mul_f32 v[68:69], v[68:69], s[60:61]
  v_pk_mul_f32 v[70:71], v[70:71], s[60:61]
  v_cvt_pk_bf16_f32 v112, v64, v65
  v_cvt_pk_bf16_f32 v113, v66, v67
  v_cvt_pk_bf16_f32 v114, v68, v69
  v_cvt_pk_bf16_f32 v115, v70, v71
  v_pk_mul_f32 v[72:73], v[72:73], s[60:61]
  v_pk_mul_f32 v[74:75], v[74:75], s[60:61]
  v_pk_mul_f32 v[76:77], v[76:77], s[60:61]
  v_pk_mul_f32 v[78:79], v[78:79], s[60:61]
  v_cvt_pk_bf16_f32 v116, v72, v73
  v_cvt_pk_bf16_f32 v117, v74, v75
  v_cvt_pk_bf16_f32 v118, v76, v77
  v_cvt_pk_bf16_f32 v119, v78, v79
  v_mov_b32 v232, 0
  v_mov_b32 v233, 0
  s_nop 0
  s_waitcnt lgkmcnt(7)
  v_mfma_f32_32x32x16_bf16 v[64:79], v[160:163], v[112:115], 0
  s_waitcnt lgkmcnt(6)
  v_mfma_f32_32x32x16_bf16 v[64:79], v[164:167], v[116:119], v[64:79]
  s_waitcnt lgkmcnt(5)
  v_mfma_f32_32x32x16_bf16 v[64:79], v[168:171], v[120:123], v[64:79]
  s_waitcnt lgkmcnt(4)
  v_mfma_f32_32x32x16_bf16 v[64:79], v[172:175], v[124:127], v[64:79]
  s_waitcnt lgkmcnt(3)
  v_mfma_f32_32x32x16_bf16 v[64:79], v[176:179], v[128:131], v[64:79]
  s_waitcnt lgkmcnt(2)
  v_mfma_f32_32x32x16_bf16 v[64:79], v[180:183], v[132:135], v[64:79]
  s_waitcnt lgkmcnt(1)
  v_mfma_f32_32x32x16_bf16 v[64:79], v[184:187], v[136:139], v[64:79]
  s_waitcnt lgkmcnt(0)
  v_mfma_f32_32x32x16_bf16 v[64:79], v[188:191], v[140:143], v[64:79]
  ds_read_b128 v[160:163], v192 offset:24576
  ds_read_b128 v[164:167], v193 offset:24576
  ds_read_b128 v[168:171], v194 offset:24576
  ds_read_b128 v[172:175], v195 offset:24576
  ds_read_b128 v[176:179], v196 offset:24576
  ds_read_b128 v[180:183], v197 offset:24576
  s_nop 7
  v_max3_f32 v204, v64, v65, v66
  v_max3_f32 v205, v67, v68, v69
  v_max3_f32 v204, v204, v70, v71
  v_max3_f32 v205, v205, v72, v73
  v_max3_f32 v204, v204, v74, v75
  v_max3_f32 v205, v205, v76, v77
  v_max3_f32 v204, v204, v78, v79
  v_max_f32 v204, v204, v205
  v_mov_b32 v205, v204
  s_nop 1
  v_permlane32_swap_b32 v204, v205
  s_nop 1
  v_max_f32 v204, v204, v205
  v_sub_f32 v96, 0, v204
  v_sub_f32 v64, v64, v204
  v_sub_f32 v97, 0, v204
  v_sub_f32 v65, v65, v204
  v_sub_f32 v98, 0, v204
  v_sub_f32 v66, v66, v204
  v_sub_f32 v99, 0, v204
  v_sub_f32 v67, v67, v204
  v_sub_f32 v100, 0, v204
  v_sub_f32 v68, v68, v204
  v_sub_f32 v101, 0, v204
  v_sub_f32 v69, v69, v204
  v_sub_f32 v102, 0, v204
  v_sub_f32 v70, v70, v204
  v_sub_f32 v103, 0, v204
  v_sub_f32 v71, v71, v204
  v_sub_f32 v104, 0, v204
  v_sub_f32 v72, v72, v204
  v_sub_f32 v105, 0, v204
  v_sub_f32 v73, v73, v204
  v_sub_f32 v106, 0, v204
  v_sub_f32 v74, v74, v204
  v_sub_f32 v107, 0, v204
  v_sub_f32 v75, v75, v204
  v_sub_f32 v108, 0, v204
  v_sub_f32 v76, v76, v204
  v_sub_f32 v109, 0, v204
  v_sub_f32 v77, v77, v204
  v_sub_f32 v110, 0, v204
  v_sub_f32 v78, v78, v204
  v_sub_f32 v111, 0, v204
  v_sub_f32 v79, v79, v204
  s_waitcnt lgkmcnt(5)
  v_mfma_f32_32x32x16_bf16 v[80:95], v[160:163], v[112:115], v[96:111]
  ds_read_b128 v[184:187], v198 offset:24576
  v_mov_b64 v[234:235], v[232:233]
  v_exp_f32 v204, v64
  v_exp_f32 v205, v65
  v_exp_f32 v206, v66
  v_exp_f32 v207, v67
  s_waitcnt lgkmcnt(5)
  v_mfma_f32_32x32x16_bf16 v[80:95], v[164:167], v[116:119], v[80:95]
  ds_read_b128 v[188:191], v199 offset:24576
  v_add_f32 v232, v232, v204
  v_add_f32 v233, v233, v205
  v_cvt_pk_bf16_f32 v144, v204, v205
  v_exp_f32 v208, v68
  v_exp_f32 v209, v69
  s_waitcnt lgkmcnt(5)
  v_mfma_f32_32x32x16_bf16 v[80:95], v[168:171], v[120:123], v[80:95]
  s_add_u32 s56, s55, 32768
  s_cmp_eq_u32 s56, 163840
  s_cselect_b32 s56, 0, s56
  s_sub_u32 s57, s56, s55
  s_mov_b32 s55, s56
  v_add_u32 v192, s57, v192
  v_add_u32 v193, s57, v193
  v_add_u32 v194, s57, v194
  v_add_u32 v195, s57, v195
  v_add_u32 v196, s57, v196
  v_add_u32 v197, s57, v197
  v_add_u32 v198, s57, v198
  v_add_u32 v199, s57, v199
  v_add_u32 v200, s57, v200
  v_add_u32 v201, s57, v201
  v_add_u32 v202, s57, v202
  v_add_u32 v203, s57, v203
  s_barrier
  ds_read_b128 v[160:163], v192 offset:16384
  v_add_f32 v232, v232, v206
  v_add_f32 v233, v233, v207
  v_cvt_pk_bf16_f32 v145, v206, v207
  v_exp_f32 v210, v70
  v_exp_f32 v211, v71
  s_waitcnt lgkmcnt(5)
  v_mfma_f32_32x32x16_bf16 v[80:95], v[172:175], v[124:127], v[80:95]
  ds_read_b128 v[164:167], v193 offset:16384
  v_add_f32 v232, v232, v208
  v_add_f32 v233, v233, v209
  v_cvt_pk_bf16_f32 v146, v208, v209
  v_exp_f32 v204, v72
  v_exp_f32 v205, v73
  s_waitcnt lgkmcnt(5)
  v_mfma_f32_32x32x16_bf16 v[80:95], v[176:179], v[128:131], v[80:95]
  ds_read_b128 v[168:171], v194 offset:16384
  v_add_f32 v232, v232, v210
  v_add_f32 v233, v233, v211
  v_cvt_pk_bf16_f32 v147, v210, v211
  v_exp_f32 v206, v74
  v_exp_f32 v207, v75
  s_waitcnt lgkmcnt(5)
  v_mfma_f32_32x32x16_bf16 v[80:95], v[180:183], v[132:135], v[80:95]
  ds_read_b128 v[172:175], v195 offset:16384
  v_add_f32 v232, v232, v204
  v_add_f32 v233, v233, v205
  v_cvt_pk_bf16_f32 v148, v204, v205
  v_exp_f32 v208, v76
  v_exp_f32 v209, v77
  s_waitcnt lgkmcnt(5)
  v_mfma_f32_32x32x16_bf16 v[80:95], v[184:187], v[136:139], v[80:95]
  ds_read_b128 v[176:179], v196 offset:16384
  v_add_f32 v232, v232, v206
  v_add_f32 v233, v233, v207
  v_cvt_pk_bf16_f32 v149, v206, v207
  v_exp_f32 v210, v78
  v_exp_f32 v211, v79
  s_waitcnt lgkmcnt(5)
  v_mfma_f32_32x32x16_bf16 v[80:95], v[188:191], v[140:143], v[80:95]
  ds_read_b128 v[180:183], v197 offset:16384
  v_add_f32 v232, v232, v208
  v_add_f32 v233, v233, v209
  v_cvt_pk_bf16_f32 v150, v208, v209
  v_add_f32 v232, v232, v210
  v_add_f32 v233, v233, v211
  v_cvt_pk_bf16_f32 v151, v210, v211
  v_add_f32 v204, v232, v233
  v_cmp_nge_f32 vcc, s59, v204
  s_cbranch_vccnz K1_RARE_0
K1_BACK_0:
  s_mov_b32 s58, 15
  .p2alignl 6, 0xBF800000
K1_LOOP:
  s_waitcnt lgkmcnt(5)
  v_mfma_f32_32x32x16_bf16 v[64:79], v[160:163], v[112:115], v[96:111]
  ds_read_b128 v[184:187], v198 offset:16384
  v_mov_b64 v[234:235], v[232:233]
  v_exp_f32 v204, v80
  s_waitcnt lgkmcnt(5)
  v_mfma_f32_32x32x16_bf16 v[64:79], v[164:167], v[116:119], v[64:79]
  ds_read_b128 v[188:191], v199 offset:16384
  v_exp_f32 v205, v81
  v_exp_f32 v206, v82
  v_exp_f32 v207, v83
  s_waitcnt lgkmcnt(5)
  v_mfma_f32_32x32x16_bf16 v[64:79], v[168:171], v[120:123], v[64:79]
  ds_read_b64_tr_b16 v[160:161], v200 offset:0
  ds_read_b64_tr_b16 v[162:163], v200 offset:2048
  v_add_f32 v232, v232, v204
  v_add_f32 v233, v233, v205
  s_waitcnt lgkmcnt(6)
  v_mfma_f32_32x32x16_bf16 v[64:79], v[172:175], v[124:127], v[64:79]
  ds_read_b64_tr_b16 v[164:165], v201 offset:0
  ds_read_b64_tr_b16 v[166:167], v201 offset:2048
  v_cvt_pk_bf16_f32 v152, v204, v205
  v_exp_f32 v208, v84
  v_exp_f32 v209, v85
  s_waitcnt lgkmcnt(7)
  v_mfma_f32_32x32x16_bf16 v[64:79], v[176:179], v[128:131], v[64:79]
  ds_read_b64_tr_b16 v[168:169], v202 offset:0
  ds_read_b64_tr_b16 v[170:171], v202 offset:2048
  v_add_f32 v232, v232, v206
  v_add_f32 v233, v233, v207
  s_waitcnt lgkmcnt(8)
  v_mfma_f32_32x32x16_bf16 v[64:79], v[180:183], v[132:135], v[64:79]
  ds_read_b64_tr_b16 v[172:173], v203 offset:0
  ds_read_b64_tr_b16 v[174:175], v203 offset:2048
  v_cvt_pk_bf16_f32 v153, v206, v207
  v_exp_f32 v210, v86
  v_exp_f32 v211, v87
  s_waitcnt lgkmcnt(9)
  v_mfma_f32_32x32x16_bf16 v[64:79], v[184:187], v[136:139], v[64:79]
  ds_read_b64_tr_b16 v[176:177], v200 offset:4096
  ds_read_b64_tr_b16 v[178:179], v200 offset:6144
  v_add_f32 v232, v232, v208
  v_add_f32 v233, v233, v209
  s_waitcnt lgkmcnt(10)
  v_mfma_f32_32x32x16_bf16 v[64:79], v[188:191], v[140:143], v[64:79]
  ds_read_b64_tr_b16 v[180:181], v201 offset:4096
  ds_read_b64_tr_b16 v[182:183], v201 offset:6144
  v_cvt_pk_bf16_f32 v154, v208, v209
  v_exp_f32 v204, v88
  v_exp_f32 v205, v89
  s_waitcnt lgkmcnt(10)
  v_mfma_f32_32x32x16_bf16 v[0:15], v[160:163], v[144:147], v[0:15]
  ds_read_b64_tr_b16 v[184:185], v202 offset:4096
  ds_read_b64_tr_b16 v[186:187], v202 offset:6144
  v_add_f32 v232, v232, v210
  v_add_f32 v233, v233, v211
  v_cvt_pk_bf16_f32 v155, v210, v211
  s_waitcnt lgkmcnt(10)
  v_mfma_f32_32x32x16_bf16 v[16:31], v[164:167], v[144:147], v[16:31]
  ds_read_b64_tr_b16 v[188:189], v203 offset:4096
  ds_read_b64_tr_b16 v[190:191], v203 offset:6144
  v_exp_f32 v206, v90
  v_exp_f32 v207, v91
  s_waitcnt lgkmcnt(10)
  v_mfma_f32_32x32x16_bf16 v[32:47], v[168:171], v[144:147], v[32:47]
  ds_read_b128 v[160:163], v192 offset:24576
  v_add_f32 v232, v232, v204
  v_add_f32 v233, v233, v205
  v_cvt_pk_bf16_f32 v156, v204, v205
  s_waitcnt lgkmcnt(9)
  v_mfma_f32_32x32x16_bf16 v[48:63], v[172:175], v[144:147], v[48:63]
  ds_read_b128 v[164:167], v193 offset:24576
  v_exp_f32 v208, v92
  v_exp_f32 v209, v93
  s_waitcnt lgkmcnt(8)
  v_mfma_f32_32x32x16_bf16 v[0:15], v[176:179], v[148:151], v[0:15]
  ds_read_b128 v[168:171], v194 offset:24576
  v_add_f32 v232, v232, v206
  v_add_f32 v233, v233, v207
  v_cvt_pk_bf16_f32 v157, v206, v207
  s_waitcnt lgkmcnt(7)
  v_mfma_f32_32x32x16_bf16 v[16:31], v[180:183], v[148:151], v[16:31]
  ds_read_b128 v[172:175], v195 offset:24576
  v_exp_f32 v210, v94
  v_exp_f32 v211, v95
  s_waitcnt lgkmcnt(6)
  v_mfma_f32_32x32x16_bf16 v[32:47], v[184:187], v[148:151], v[32:47]
  ds_read_b128 v[176:179], v196 offset:24576
  v_add_f32 v232, v232, v208
  v_add_f32 v233, v233, v209
  v_cvt_pk_bf16_f32 v158, v208, v209
  s_waitcnt lgkmcnt(5)
  v_mfma_f32_32x32x16_bf16 v[48:63], v[188:191], v[148:151], v[48:63]
  ds_read_b128 v[180:183], v197 offset:24576
  v_add_f32 v232, v232, v210
  v_add_f32 v233, v233, v211
  v_cvt_pk_bf16_f32 v159, v210, v211
  v_add_f32 v204, v232, v233
  v_cmp_nge_f32 vcc, s59, v204
  s_cbranch_vccnz K1_RARE_1
K1_BACK_1:
  s_waitcnt lgkmcnt(5)
  v_mfma_f32_32x32x16_bf16 v[80:95], v[160:163], v[112:115], v[96:111]
  ds_read_b128 v[184:187], v198 offset:24576
  v_mov_b64 v[234:235], v[232:233]
  v_exp_f32 v204, v64
  s_waitcnt lgkmcnt(5)
  v_mfma_f32_32x32x16_bf16 v[80:95], v[164:167], v[116:119], v[80:95]
  ds_read_b128 v[188:191], v199 offset:24576
  v_exp_f32 v205, v65
  v_exp_f32 v206, v66
  v_exp_f32 v207, v67
  s_waitcnt lgkmcnt(5)
  v_mfma_f32_32x32x16_bf16 v[80:95], v[168:171], v[120:123], v[80:95]
  ds_read_b64_tr_b16 v[160:161], v200 offset:8192
  ds_read_b64_tr_b16 v[162:163], v200 offset:10240
  v_add_f32 v232, v232, v204
  v_add_f32 v233, v233, v205
  s_waitcnt lgkmcnt(6)
  v_mfma_f32_32x32x16_bf16 v[80:95], v[172:175], v[124:127], v[80:95]
  ds_read_b64_tr_b16 v[164:165], v201 offset:8192
  ds_read_b64_tr_b16 v[166:167], v201 offset:10240
  v_cvt_pk_bf16_f32 v144, v204, v205
  v_exp_f32 v208, v68
  v_exp_f32 v209, v69
  s_waitcnt lgkmcnt(7)
  v_mfma_f32_32x32x16_bf16 v[80:95], v[176:179], v[128:131], v[80:95]
  ds_read_b64_tr_b16 v[168:169], v202 offset:8192
  ds_read_b64_tr_b16 v[170:171], v202 offset:10240
  v_add_f32 v232, v232, v206
  v_add_f32 v233, v233, v207
  s_waitcnt lgkmcnt(8)
  v_mfma_f32_32x32x16_bf16 v[80:95], v[180:183], v[132:135], v[80:95]
  ds_read_b64_tr_b16 v[172:173], v203 offset:8192
  ds_read_b64_tr_b16 v[174:175], v203 offset:10240
  v_cvt_pk_bf16_f32 v145, v206, v207
  v_exp_f32 v210, v70
  v_exp_f32 v211, v71
  s_waitcnt lgkmcnt(9)
  v_mfma_f32_32x32x16_bf16 v[80:95], v[184:187], v[136:139], v[80:95]
  ds_read_b64_tr_b16 v[176:177], v200 offset:12288
  ds_read_b64_tr_b16 v[178:179], v200 offset:14336
  v_add_f32 v232, v232, v208
  v_add_f32 v233, v233, v209
  s_waitcnt lgkmcnt(10)
  v_mfma_f32_32x32x16_bf16 v[80:95], v[188:191], v[140:143], v[80:95]
  ds_read_b64_tr_b16 v[180:181], v201 offset:12288
  ds_read_b64_tr_b16 v[182:183], v201 offset:14336
  v_cvt_pk_bf16_f32 v146, v208, v209
  v_exp_f32 v204, v72
  v_exp_f32 v205, v73
  s_waitcnt lgkmcnt(10)
  v_mfma_f32_32x32x16_bf16 v[0:15], v[160:163], v[152:155], v[0:15]
  ds_read_b64_tr_b16 v[184:185], v202 offset:12288
  ds_read_b64_tr_b16 v[186:187], v202 offset:14336
  v_add_f32 v232, v232, v210
  v_add_f32 v233, v233, v211
  v_cvt_pk_bf16_f32 v147, v210, v211
  s_waitcnt lgkmcnt(10)
  v_mfma_f32_32x32x16_bf16 v[16:31], v[164:167], v[152:155], v[16:31]
  ds_read_b64_tr_b16 v[188:189], v203 offset:12288
  ds_read_b64_tr_b16 v[190:191], v203 offset:14336
  v_exp_f32 v206, v74
  v_exp_f32 v207, v75
  s_waitcnt lgkmcnt(10)
  v_mfma_f32_32x32x16_bf16 v[32:47], v[168:171], v[152:155], v[32:47]
  s_add_u32 s56, s55, 32768
  s_cmp_eq_u32 s56, 163840
  s_cselect_b32 s56, 0, s56
  s_sub_u32 s57, s56, s55
  s_mov_b32 s55, s56
  v_add_u32 v192, s57, v192
  v_add_u32 v193, s57, v193
  v_add_u32 v194, s57, v194
  v_add_u32 v195, s57, v195
  v_add_u32 v196, s57, v196
  v_add_u32 v197, s57, v197
  v_add_u32 v198, s57, v198
  v_add_u32 v199, s57, v199
  v_add_u32 v200, s57, v200
  v_add_u32 v201, s57, v201
  v_add_u32 v202, s57, v202
  v_add_u32 v203, s57, v203
  s_barrier
  ds_read_b128 v[160:163], v192 offset:16384
  v_add_f32 v232, v232, v204
  v_add_f32 v233, v233, v205
  v_cvt_pk_bf16_f32 v148, v204, v205
  s_waitcnt lgkmcnt(9)
  v_mfma_f32_32x32x16_bf16 v[48:63], v[172:175], v[152:155], v[48:63]
  ds_read_b128 v[164:167], v193 offset:16384
  v_exp_f32 v208, v76
  v_exp_f32 v209, v77
  s_waitcnt lgkmcnt(8)
  v_mfma_f32_32x32x16_bf16 v[0:15], v[176:179], v[156:159], v[0:15]
  ds_read_b128 v[168:171], v194 offset:16384
  v_add_f32 v232, v232, v206
  v_add_f32 v233, v233, v207
  v_cvt_pk_bf16_f32 v149, v206, v207
  s_waitcnt lgkmcnt(7)
  v_mfma_f32_32x32x16_bf16 v[16:31], v[180:183], v[156:159], v[16:31]
  ds_read_b128 v[172:175], v195 offset:16384
  v_exp_f32 v210, v78
  v_exp_f32 v211, v79
  s_waitcnt lgkmcnt(6)
  v_mfma_f32_32x32x16_bf16 v[32:47], v[184:187], v[156:159], v[32:47]
  ds_read_b128 v[176:179], v196 offset:16384
  v_add_f32 v232, v232, v208
  v_add_f32 v233, v233, v209
  v_cvt_pk_bf16_f32 v150, v208, v209
  s_waitcnt lgkmcnt(5)
  v_mfma_f32_32x32x16_bf16 v[48:63], v[188:191], v[156:159], v[48:63]
  ds_read_b128 v[180:183], v197 offset:16384
  v_add_f32 v232, v232, v210
  v_add_f32 v233, v233, v211
  v_cvt_pk_bf16_f32 v151, v210, v211
  v_add_f32 v204, v232, v233
  v_cmp_nge_f32 vcc, s59, v204
  s_cbranch_vccnz K1_RARE_2
K1_BACK_2:
  s_sub_u32 s58, s58, 1
  s_cmp_lg_u32 s58, 0
  s_cbranch_scc1 K1_LOOP
  s_waitcnt lgkmcnt(0)
  ds_read_b64_tr_b16 v[160:161], v200 offset:0
  ds_read_b64_tr_b16 v[162:163], v200 offset:2048
  ds_read_b64_tr_b16 v[164:165], v201 offset:0
  ds_read_b64_tr_b16 v[166:167], v201 offset:2048
  ds_read_b64_tr_b16 v[168:169], v202 offset:0
  ds_read_b64_tr_b16 v[170:171], v202 offset:2048
  ds_read_b64_tr_b16 v[172:173], v203 offset:0
  ds_read_b64_tr_b16 v[174:175], v203 offset:2048
  ds_read_b64_tr_b16 v[176:177], v200 offset:4096
  ds_read_b64_tr_b16 v[178:179], v200 offset:6144
  ds_read_b64_tr_b16 v[180:181], v201 offset:4096
  ds_read_b64_tr_b16 v[182:183], v201 offset:6144
  s_waitcnt lgkmcnt(10)
  v_mfma_f32_32x32x16_bf16 v[0:15], v[160:163], v[144:147], v[0:15]
  ds_read_b64_tr_b16 v[184:185], v202 offset:4096
  ds_read_b64_tr_b16 v[186:187], v202 offset:6144
  v_mov_b64 v[234:235], v[232:233]
  v_exp_f32 v204, v80
  v_exp_f32 v205, v81
  v_exp_f32 v206, v82
  v_exp_f32 v207, v83
  s_waitcnt lgkmcnt(10)
  v_mfma_f32_32x32x16_bf16 v[16:31], v[164:167], v[144:147], v[16:31]
  ds_read_b64_tr_b16 v[188:189], v203 offset:4096
  ds_read_b64_tr_b16 v[190:191], v203 offset:6144
  v_add_f32 v232, v232, v204
  v_add_f32 v233, v233, v205
  v_cvt_pk_bf16_f32 v152, v204, v205
  v_exp_f32 v208, v84
  v_exp_f32 v209, v85
  s_waitcnt lgkmcnt(10)
  v_mfma_f32_32x32x16_bf16 v[32:47], v[168:171], v[144:147], v[32:47]
  ds_read_b64_tr_b16 v[160:161], v200 offset:8192
  ds_read_b64_tr_b16 v[162:163], v200 offset:10240
  v_add_f32 v232, v232, v206
  v_add_f32 v233, v233, v207
  v_cvt_pk_bf16_f32 v153, v206, v207
  v_exp_f32 v210, v86
  v_exp_f32 v211, v87
  s_waitcnt lgkmcnt(10)
  v_mfma_f32_32x32x16_bf16 v[48:63], v[172:175], v[144:147], v[48:63]
  ds_read_b64_tr_b16 v[164:165], v201 offset:8192
  ds_read_b64_tr_b16 v[166:167], v201 offset:10240
  v_add_f32 v232, v232, v208
  v_add_f32 v233, v233, v209
  v_cvt_pk_bf16_f32 v154, v208, v209
  v_exp_f32 v204, v88
  v_exp_f32 v205, v89
  s_waitcnt lgkmcnt(10)
  v_mfma_f32_32x32x16_bf16 v[0:15], v[176:179], v[148:151], v[0:15]
  ds_read_b64_tr_b16 v[168:169], v202 offset:8192
  ds_read_b64_tr_b16 v[170:171], v202 offset:10240
  v_add_f32 v232, v232, v210
  v_add_f32 v233, v233, v211
  v_cvt_pk_bf16_f32 v155, v210, v211
  v_exp_f32 v206, v90
  v_exp_f32 v207, v91
  s_waitcnt lgkmcnt(10)
  v_mfma_f32_32x32x16_bf16 v[16:31], v[180:183], v[148:151], v[16:31]
  ds_read_b64_tr_b16 v[172:173], v203 offset:8192
  ds_read_b64_tr_b16 v[174:175], v203 offset:10240
  v_add_f32 v232, v232, v204
  v_add_f32 v233, v233, v205
  v_cvt_pk_bf16_f32 v156, v204, v205
  v_exp_f32 v208, v92
  v_exp_f32 v209, v93
  s_waitcnt lgkmcnt(10)
  v_mfma_f32_32x32x16_bf16 v[32:47], v[184:187], v[148:151], v[32:47]
  ds_read_b64_tr_b16 v[176:177], v200 offset:12288
  ds_read_b64_tr_b16 v[178:179], v200 offset:14336
  v_add_f32 v232, v232, v206
  v_add_f32 v233, v233, v207
  v_cvt_pk_bf16_f32 v157, v206, v207
  v_exp_f32 v210, v94
  v_exp_f32 v211, v95
  s_waitcnt lgkmcnt(10)
  v_mfma_f32_32x32x16_bf16 v[48:63], v[188:191], v[148:151], v[48:63]
  ds_read_b64_tr_b16 v[180:181], v201 offset:12288
  ds_read_b64_tr_b16 v[182:183], v201 offset:14336
  v_add_f32 v232, v232, v208
  v_add_f32 v233, v233, v209
  v_cvt_pk_bf16_f32 v158, v208, v209
  v_add_f32 v232, v232, v210
  v_add_f32 v233, v233, v211
  v_cvt_pk_bf16_f32 v159, v210, v211
  v_add_f32 v204, v232, v233
  v_cmp_nge_f32 vcc, s59, v204
  s_cbranch_vccnz K1_RARE_31
K1_BACK_31:
  s_waitcnt lgkmcnt(10)
  v_mfma_f32_32x32x16_bf16 v[0:15], v[160:163], v[152:155], v[0:15]
  ds_read_b64_tr_b16 v[184:185], v202 offset:12288
  ds_read_b64_tr_b16 v[186:187], v202 offset:14336
  s_waitcnt lgkmcnt(10)
  v_mfma_f32_32x32x16_bf16 v[16:31], v[164:167], v[152:155], v[16:31]
  ds_read_b64_tr_b16 v[188:189], v203 offset:12288
  ds_read_b64_tr_b16 v[190:191], v203 offset:14336
  s_waitcnt lgkmcnt(10)
  v_mfma_f32_32x32x16_bf16 v[32:47], v[168:171], v[152:155], v[32:47]
  s_waitcnt lgkmcnt(8)
  v_mfma_f32_32x32x16_bf16 v[48:63], v[172:175], v[152:155], v[48:63]
  s_waitcnt lgkmcnt(6)
  v_mfma_f32_32x32x16_bf16 v[0:15], v[176:179], v[156:159], v[0:15]
  s_waitcnt lgkmcnt(4)
  v_mfma_f32_32x32x16_bf16 v[16:31], v[180:183], v[156:159], v[16:31]
  s_waitcnt lgkmcnt(2)
  v_mfma_f32_32x32x16_bf16 v[32:47], v[184:187], v[156:159], v[32:47]
  s_waitcnt lgkmcnt(0)
  v_mfma_f32_32x32x16_bf16 v[48:63], v[188:191], v[156:159], v[48:63]
  s_nop 15
  v_add_f32 v204, v232, v233
  v_add_f32 v205, v232, v233
  s_nop 1
  v_permlane32_swap_b32 v204, v205
  s_nop 1
  v_add_f32 v204, v204, v205
  v_rcp_f32 v204, v204
  s_mul_i32 s48, s28, 7
  s_add_u32 s48, s48, s30
  s_lshl_b32 s48, s48, 8
  s_lshl_b32 s49, s29, 3
  s_add_u32 s48, s48, s49
  s_lshl_b32 s48, s48, 10
  s_add_u32 s49, s48, 4096
  v_lshlrev_b32 v205, 4, v220
  v_mul_f32 v0, v204, v0
  v_mul_f32 v1, v204, v1
  v_cvt_pk_bf16_f32 v160, v0, v1
  v_mul_f32 v2, v204, v2
  v_mul_f32 v3, v204, v3
  v_cvt_pk_bf16_f32 v161, v2, v3
  v_mul_f32 v4, v204, v4
  v_mul_f32 v5, v204, v5
  v_cvt_pk_bf16_f32 v162, v4, v5
  v_mul_f32 v6, v204, v6
  v_mul_f32 v7, v204, v7
  v_cvt_pk_bf16_f32 v163, v6, v7
  buffer_store_dwordx4 v[160:163], v205, s[20:23], s48 offen offset:0 sc0 sc1
  v_mul_f32 v8, v204, v8
  v_mul_f32 v9, v204, v9
  v_cvt_pk_bf16_f32 v164, v8, v9
  v_mul_f32 v10, v204, v10
  v_mul_f32 v11, v204, v11
  v_cvt_pk_bf16_f32 v165, v10, v11
  v_mul_f32 v12, v204, v12
  v_mul_f32 v13, v204, v13
  v_cvt_pk_bf16_f32 v166, v12, v13
  v_mul_f32 v14, v204, v14
  v_mul_f32 v15, v204, v15
  v_cvt_pk_bf16_f32 v167, v14, v15
  buffer_store_dwordx4 v[164:167], v205, s[20:23], s48 offen offset:1024 sc0 sc1
  v_mul_f32 v16, v204, v16
  v_mul_f32 v17, v204, v17
  v_cvt_pk_bf16_f32 v168, v16, v17
  v_mul_f32 v18, v204, v18
  v_mul_f32 v19, v204, v19
  v_cvt_pk_bf16_f32 v169, v18, v19
  v_mul_f32 v20, v204, v20
  v_mul_f32 v21, v204, v21
  v_cvt_pk_bf16_f32 v170, v20, v21
  v_mul_f32 v22, v204, v22
  v_mul_f32 v23, v204, v23
  v_cvt_pk_bf16_f32 v171, v22, v23
  buffer_store_dwordx4 v[168:171], v205, s[20:23], s48 offen offset:2048 sc0 sc1
  v_mul_f32 v24, v204, v24
  v_mul_f32 v25, v204, v25
  v_cvt_pk_bf16_f32 v172, v24, v25
  v_mul_f32 v26, v204, v26
  v_mul_f32 v27, v204, v27
  v_cvt_pk_bf16_f32 v173, v26, v27
  v_mul_f32 v28, v204, v28
  v_mul_f32 v29, v204, v29
  v_cvt_pk_bf16_f32 v174, v28, v29
  v_mul_f32 v30, v204, v30
  v_mul_f32 v31, v204, v31
  v_cvt_pk_bf16_f32 v175, v30, v31
  buffer_store_dwordx4 v[172:175], v205, s[20:23], s48 offen offset:3072 sc0 sc1
  v_mul_f32 v32, v204, v32
  v_mul_f32 v33, v204, v33
  v_cvt_pk_bf16_f32 v176, v32, v33
  v_mul_f32 v34, v204, v34
  v_mul_f32 v35, v204, v35
  v_cvt_pk_bf16_f32 v177, v34, v35
  v_mul_f32 v36, v204, v36
  v_mul_f32 v37, v204, v37
  v_cvt_pk_bf16_f32 v178, v36, v37
  v_mul_f32 v38, v204, v38
  v_mul_f32 v39, v204, v39
  v_cvt_pk_bf16_f32 v179, v38, v39
  buffer_store_dwordx4 v[176:179], v205, s[20:23], s49 offen offset:0 sc0 sc1
  v_mul_f32 v40, v204, v40
  v_mul_f32 v41, v204, v41
  v_cvt_pk_bf16_f32 v180, v40, v41
  v_mul_f32 v42, v204, v42
  v_mul_f32 v43, v204, v43
  v_cvt_pk_bf16_f32 v181, v42, v43
  v_mul_f32 v44, v204, v44
  v_mul_f32 v45, v204, v45
  v_cvt_pk_bf16_f32 v182, v44, v45
  v_mul_f32 v46, v204, v46
  v_mul_f32 v47, v204, v47
  v_cvt_pk_bf16_f32 v183, v46, v47
  buffer_store_dwordx4 v[180:183], v205, s[20:23], s49 offen offset:1024 sc0 sc1
  v_mul_f32 v48, v204, v48
  v_mul_f32 v49, v204, v49
  v_cvt_pk_bf16_f32 v184, v48, v49
  v_mul_f32 v50, v204, v50
  v_mul_f32 v51, v204, v51
  v_cvt_pk_bf16_f32 v185, v50, v51
  v_mul_f32 v52, v204, v52
  v_mul_f32 v53, v204, v53
  v_cvt_pk_bf16_f32 v186, v52, v53
  v_mul_f32 v54, v204, v54
  v_mul_f32 v55, v204, v55
  v_cvt_pk_bf16_f32 v187, v54, v55
  buffer_store_dwordx4 v[184:187], v205, s[20:23], s49 offen offset:2048 sc0 sc1
  v_mul_f32 v56, v204, v56
  v_mul_f32 v57, v204, v57
  v_cvt_pk_bf16_f32 v188, v56, v57
  v_mul_f32 v58, v204, v58
  v_mul_f32 v59, v204, v59
  v_cvt_pk_bf16_f32 v189, v58, v59
  v_mul_f32 v60, v204, v60
  v_mul_f32 v61, v204, v61
  v_cvt_pk_bf16_f32 v190, v60, v61
  v_mul_f32 v62, v204, v62
  v_mul_f32 v63, v204, v63
  v_cvt_pk_bf16_f32 v191, v62, v63
  buffer_store_dwordx4 v[188:191], v205, s[20:23], s49 offen offset:3072 sc0 sc1
  s_endpgm
K1_RARE_0:
  s_nop 15
  s_nop 3
  v_max3_f32 v204, v64, v65, v66
  v_max3_f32 v205, v67, v68, v69
  v_max3_f32 v204, v204, v70, v71
  v_max3_f32 v205, v205, v72, v73
  v_max3_f32 v204, v204, v74, v75
  v_max3_f32 v205, v205, v76, v77
  v_max3_f32 v204, v204, v78, v79
  v_max_f32 v204, v204, v205
  v_mov_b32 v205, v204
  s_nop 1
  v_permlane32_swap_b32 v204, v205
  s_nop 1
  v_max_f32 v204, v204, v205
  v_max_f32 v204, 0, v204
  v_exp_f32 v205, -v204
  s_nop 0
  v_mul_f32 v0, v205, v0
  v_mul_f32 v1, v205, v1
  v_mul_f32 v2, v205, v2
  v_mul_f32 v3, v205, v3
  v_mul_f32 v4, v205, v4
  v_mul_f32 v5, v205, v5
  v_mul_f32 v6, v205, v6
  v_mul_f32 v7, v205, v7
  v_mul_f32 v8, v205, v8
  v_mul_f32 v9, v205, v9
  v_mul_f32 v10, v205, v10
  v_mul_f32 v11, v205, v11
  v_mul_f32 v12, v205, v12
  v_mul_f32 v13, v205, v13
  v_mul_f32 v14, v205, v14
  v_mul_f32 v15, v205, v15
  v_mul_f32 v16, v205, v16
  v_mul_f32 v17, v205, v17
  v_mul_f32 v18, v205, v18
  v_mul_f32 v19, v205, v19
  v_mul_f32 v20, v205, v20
  v_mul_f32 v21, v205, v21
  v_mul_f32 v22, v205, v22
  v_mul_f32 v23, v205, v23
  v_mul_f32 v24, v205, v24
  v_mul_f32 v25, v205, v25
  v_mul_f32 v26, v205, v26
  v_mul_f32 v27, v205, v27
  v_mul_f32 v28, v205, v28
  v_mul_f32 v29, v205, v29
  v_mul_f32 v30, v205, v30
  v_mul_f32 v31, v205, v31
  v_mul_f32 v32, v205, v32
  v_mul_f32 v33, v205, v33
  v_mul_f32 v34, v205, v34
  v_mul_f32 v35, v205, v35
  v_mul_f32 v36, v205, v36
  v_mul_f32 v37, v205, v37
  v_mul_f32 v38, v205, v38
  v_mul_f32 v39, v205, v39
  v_mul_f32 v40, v205, v40
  v_mul_f32 v41, v205, v41
  v_mul_f32 v42, v205, v42
  v_mul_f32 v43, v205, v43
  v_mul_f32 v44, v205, v44
  v_mul_f32 v45, v205, v45
  v_mul_f32 v46, v205, v46
  v_mul_f32 v47, v205, v47
  v_mul_f32 v48, v205, v48
  v_mul_f32 v49, v205, v49
  v_mul_f32 v50, v205, v50
  v_mul_f32 v51, v205, v51
  v_mul_f32 v52, v205, v52
  v_mul_f32 v53, v205, v53
  v_mul_f32 v54, v205, v54
  v_mul_f32 v55, v205, v55
  v_mul_f32 v56, v205, v56
  v_mul_f32 v57, v205, v57
  v_mul_f32 v58, v205, v58
  v_mul_f32 v59, v205, v59
  v_mul_f32 v60, v205, v60
  v_mul_f32 v61, v205, v61
  v_mul_f32 v62, v205, v62
  v_mul_f32 v63, v205, v63
  v_mul_f32 v232, v205, v234
  v_mul_f32 v233, v205, v235
  v_sub_f32 v96, v96, v204
  v_sub_f32 v64, v64, v204
  v_sub_f32 v80, v80, v204
  v_sub_f32 v97, v97, v204
  v_sub_f32 v65, v65, v204
  v_sub_f32 v81, v81, v204
  v_sub_f32 v98, v98, v204
  v_sub_f32 v66, v66, v204
  v_sub_f32 v82, v82, v204
  v_sub_f32 v99, v99, v204
  v_sub_f32 v67, v67, v204
  v_sub_f32 v83, v83, v204
  v_sub_f32 v100, v100, v204
  v_sub_f32 v68, v68, v204
  v_sub_f32 v84, v84, v204
  v_sub_f32 v101, v101, v204
  v_sub_f32 v69, v69, v204
  v_sub_f32 v85, v85, v204
  v_sub_f32 v102, v102, v204
  v_sub_f32 v70, v70, v204
  v_sub_f32 v86, v86, v204
  v_sub_f32 v103, v103, v204
  v_sub_f32 v71, v71, v204
  v_sub_f32 v87, v87, v204
  v_sub_f32 v104, v104, v204
  v_sub_f32 v72, v72, v204
  v_sub_f32 v88, v88, v204
  v_sub_f32 v105, v105, v204
  v_sub_f32 v73, v73, v204
  v_sub_f32 v89, v89, v204
  v_sub_f32 v106, v106, v204
  v_sub_f32 v74, v74, v204
  v_sub_f32 v90, v90, v204
  v_sub_f32 v107, v107, v204
  v_sub_f32 v75, v75, v204
  v_sub_f32 v91, v91, v204
  v_sub_f32 v108, v108, v204
  v_sub_f32 v76, v76, v204
  v_sub_f32 v92, v92, v204
  v_sub_f32 v109, v109, v204
  v_sub_f32 v77, v77, v204
  v_sub_f32 v93, v93, v204
  v_sub_f32 v110, v110, v204
  v_sub_f32 v78, v78, v204
  v_sub_f32 v94, v94, v204
  v_sub_f32 v111, v111, v204
  v_sub_f32 v79, v79, v204
  v_sub_f32 v95, v95, v204
  v_exp_f32 v204, v64
  v_exp_f32 v205, v65
  v_exp_f32 v206, v66
  v_exp_f32 v207, v67
  v_add_f32 v232, v232, v204
  v_add_f32 v233, v233, v205
  v_cvt_pk_bf16_f32 v144, v204, v205
  v_exp_f32 v208, v68
  v_exp_f32 v209, v69
  v_add_f32 v232, v232, v206
  v_add_f32 v233, v233, v207
  v_cvt_pk_bf16_f32 v145, v206, v207
  v_exp_f32 v210, v70
  v_exp_f32 v211, v71
  v_add_f32 v232, v232, v208
  v_add_f32 v233, v233, v209
  v_cvt_pk_bf16_f32 v146, v208, v209
  v_exp_f32 v204, v72
  v_exp_f32 v205, v73
  v_add_f32 v232, v232, v210
  v_add_f32 v233, v233, v211
  v_cvt_pk_bf16_f32 v147, v210, v211
  v_exp_f32 v206, v74
  v_exp_f32 v207, v75
  v_add_f32 v232, v232, v204
  v_add_f32 v233, v233, v205
  v_cvt_pk_bf16_f32 v148, v204, v205
  v_exp_f32 v208, v76
  v_exp_f32 v209, v77
  v_add_f32 v232, v232, v206
  v_add_f32 v233, v233, v207
  v_cvt_pk_bf16_f32 v149, v206, v207
  v_exp_f32 v210, v78
  v_exp_f32 v211, v79
  v_add_f32 v232, v232, v208
  v_add_f32 v233, v233, v209
  v_cvt_pk_bf16_f32 v150, v208, v209
  v_add_f32 v232, v232, v210
  v_add_f32 v233, v233, v211
  v_cvt_pk_bf16_f32 v151, v210, v211
  s_nop 1
  s_branch K1_BACK_0
K1_RARE_1:
  s_nop 15
  s_nop 3
  v_max3_f32 v204, v80, v81, v82
  v_max3_f32 v205, v83, v84, v85
  v_max3_f32 v204, v204, v86, v87
  v_max3_f32 v205, v205, v88, v89
  v_max3_f32 v204, v204, v90, v91
  v_max3_f32 v205, v205, v92, v93
  v_max3_f32 v204, v204, v94, v95
  v_max_f32 v204, v204, v205
  v_mov_b32 v205, v204
  s_nop 1
  v_permlane32_swap_b32 v204, v205
  s_nop 1
  v_max_f32 v204, v204, v205
  v_max_f32 v204, 0, v204
  v_exp_f32 v205, -v204
  s_nop 0
  v_mul_f32 v0, v205, v0
  v_mul_f32 v1, v205, v1
  v_mul_f32 v2, v205, v2
  v_mul_f32 v3, v205, v3
  v_mul_f32 v4, v205, v4
  v_mul_f32 v5, v205, v5
  v_mul_f32 v6, v205, v6
  v_mul_f32 v7, v205, v7
  v_mul_f32 v8, v205, v8
  v_mul_f32 v9, v205, v9
  v_mul_f32 v10, v205, v10
  v_mul_f32 v11, v205, v11
  v_mul_f32 v12, v205, v12
  v_mul_f32 v13, v205, v13
  v_mul_f32 v14, v205, v14
  v_mul_f32 v15, v205, v15
  v_mul_f32 v16, v205, v16
  v_mul_f32 v17, v205, v17
  v_mul_f32 v18, v205, v18
  v_mul_f32 v19, v205, v19
  v_mul_f32 v20, v205, v20
  v_mul_f32 v21, v205, v21
  v_mul_f32 v22, v205, v22
  v_mul_f32 v23, v205, v23
  v_mul_f32 v24, v205, v24
  v_mul_f32 v25, v205, v25
  v_mul_f32 v26, v205, v26
  v_mul_f32 v27, v205, v27
  v_mul_f32 v28, v205, v28
  v_mul_f32 v29, v205, v29
  v_mul_f32 v30, v205, v30
  v_mul_f32 v31, v205, v31
  v_mul_f32 v32, v205, v32
  v_mul_f32 v33, v205, v33
  v_mul_f32 v34, v205, v34
  v_mul_f32 v35, v205, v35
  v_mul_f32 v36, v205, v36
  v_mul_f32 v37, v205, v37
  v_mul_f32 v38, v205, v38
  v_mul_f32 v39, v205, v39
  v_mul_f32 v40, v205, v40
  v_mul_f32 v41, v205, v41
  v_mul_f32 v42, v205, v42
  v_mul_f32 v43, v205, v43
  v_mul_f32 v44, v205, v44
  v_mul_f32 v45, v205, v45
  v_mul_f32 v46, v205, v46
  v_mul_f32 v47, v205, v47
  v_mul_f32 v48, v205, v48
  v_mul_f32 v49, v205, v49
  v_mul_f32 v50, v205, v50
  v_mul_f32 v51, v205, v51
  v_mul_f32 v52, v205, v52
  v_mul_f32 v53, v205, v53
  v_mul_f32 v54, v205, v54
  v_mul_f32 v55, v205, v55
  v_mul_f32 v56, v205, v56
  v_mul_f32 v57, v205, v57
  v_mul_f32 v58, v205, v58
  v_mul_f32 v59, v205, v59
  v_mul_f32 v60, v205, v60
  v_mul_f32 v61, v205, v61
  v_mul_f32 v62, v205, v62
  v_mul_f32 v63, v205, v63
  v_mul_f32 v232, v205, v234
  v_mul_f32 v233, v205, v235
  v_sub_f32 v96, v96, v204
  v_sub_f32 v64, v64, v204
  v_sub_f32 v80, v80, v204
  v_sub_f32 v97, v97, v204
  v_sub_f32 v65, v65, v204
  v_sub_f32 v81, v81, v204
  v_sub_f32 v98, v98, v204
  v_sub_f32 v66, v66, v204
  v_sub_f32 v82, v82, v204
  v_sub_f32 v99, v99, v204
  v_sub_f32 v67, v67, v204
  v_sub_f32 v83, v83, v204
  v_sub_f32 v100, v100, v204
  v_sub_f32 v68, v68, v204
  v_sub_f32 v84, v84, v204
  v_sub_f32 v101, v101, v204
  v_sub_f32 v69, v69, v204
  v_sub_f32 v85, v85, v204
  v_sub_f32 v102, v102, v204
  v_sub_f32 v70, v70, v204
  v_sub_f32 v86, v86, v204
  v_sub_f32 v103, v103, v204
  v_sub_f32 v71, v71, v204
  v_sub_f32 v87, v87, v204
  v_sub_f32 v104, v104, v204
  v_sub_f32 v72, v72, v204
  v_sub_f32 v88, v88, v204
  v_sub_f32 v105, v105, v204
  v_sub_f32 v73, v73, v204
  v_sub_f32 v89, v89, v204
  v_sub_f32 v106, v106, v204
  v_sub_f32 v74, v74, v204
  v_sub_f32 v90, v90, v204
  v_sub_f32 v107, v107, v204
  v_sub_f32 v75, v75, v204
  v_sub_f32 v91, v91, v204
  v_sub_f32 v108, v108, v204
  v_sub_f32 v76, v76, v204
  v_sub_f32 v92, v92, v204
  v_sub_f32 v109, v109, v204
  v_sub_f32 v77, v77, v204
  v_sub_f32 v93, v93, v204
  v_sub_f32 v110, v110, v204
  v_sub_f32 v78, v78, v204
  v_sub_f32 v94, v94, v204
  v_sub_f32 v111, v111, v204
  v_sub_f32 v79, v79, v204
  v_sub_f32 v95, v95, v204
  v_exp_f32 v204, v80
  v_exp_f32 v205, v81
  v_exp_f32 v206, v82
  v_exp_f32 v207, v83
  v_add_f32 v232, v232, v204
  v_add_f32 v233, v233, v205
  v_cvt_pk_bf16_f32 v152, v204, v205
  v_exp_f32 v208, v84
  v_exp_f32 v209, v85
  v_add_f32 v232, v232, v206
  v_add_f32 v233, v233, v207
  v_cvt_pk_bf16_f32 v153, v206, v207
  v_exp_f32 v210, v86
  v_exp_f32 v211, v87
  v_add_f32 v232, v232, v208
  v_add_f32 v233, v233, v209
  v_cvt_pk_bf16_f32 v154, v208, v209
  v_exp_f32 v204, v88
  v_exp_f32 v205, v89
  v_add_f32 v232, v232, v210
  v_add_f32 v233, v233, v211
  v_cvt_pk_bf16_f32 v155, v210, v211
  v_exp_f32 v206, v90
  v_exp_f32 v207, v91
  v_add_f32 v232, v232, v204
  v_add_f32 v233, v233, v205
  v_cvt_pk_bf16_f32 v156, v204, v205
  v_exp_f32 v208, v92
  v_exp_f32 v209, v93
  v_add_f32 v232, v232, v206
  v_add_f32 v233, v233, v207
  v_cvt_pk_bf16_f32 v157, v206, v207
  v_exp_f32 v210, v94
  v_exp_f32 v211, v95
  v_add_f32 v232, v232, v208
  v_add_f32 v233, v233, v209
  v_cvt_pk_bf16_f32 v158, v208, v209
  v_add_f32 v232, v232, v210
  v_add_f32 v233, v233, v211
  v_cvt_pk_bf16_f32 v159, v210, v211
  s_nop 1
  s_branch K1_BACK_1
K1_RARE_2:
  s_nop 15
  s_nop 3
  v_max3_f32 v204, v64, v65, v66
  v_max3_f32 v205, v67, v68, v69
  v_max3_f32 v204, v204, v70, v71
  v_max3_f32 v205, v205, v72, v73
  v_max3_f32 v204, v204, v74, v75
  v_max3_f32 v205, v205, v76, v77
  v_max3_f32 v204, v204, v78, v79
  v_max_f32 v204, v204, v205
  v_mov_b32 v205, v204
  s_nop 1
  v_permlane32_swap_b32 v204, v205
  s_nop 1
  v_max_f32 v204, v204, v205
  v_max_f32 v204, 0, v204
  v_exp_f32 v205, -v204
  s_nop 0
  v_mul_f32 v0, v205, v0
  v_mul_f32 v1, v205, v1
  v_mul_f32 v2, v205, v2
  v_mul_f32 v3, v205, v3
  v_mul_f32 v4, v205, v4
  v_mul_f32 v5, v205, v5
  v_mul_f32 v6, v205, v6
  v_mul_f32 v7, v205, v7
  v_mul_f32 v8, v205, v8
  v_mul_f32 v9, v205, v9
  v_mul_f32 v10, v205, v10
  v_mul_f32 v11, v205, v11
  v_mul_f32 v12, v205, v12
  v_mul_f32 v13, v205, v13
  v_mul_f32 v14, v205, v14
  v_mul_f32 v15, v205, v15
  v_mul_f32 v16, v205, v16
  v_mul_f32 v17, v205, v17
  v_mul_f32 v18, v205, v18
  v_mul_f32 v19, v205, v19
  v_mul_f32 v20, v205, v20
  v_mul_f32 v21, v205, v21
  v_mul_f32 v22, v205, v22
  v_mul_f32 v23, v205, v23
  v_mul_f32 v24, v205, v24
  v_mul_f32 v25, v205, v25
  v_mul_f32 v26, v205, v26
  v_mul_f32 v27, v205, v27
  v_mul_f32 v28, v205, v28
  v_mul_f32 v29, v205, v29
  v_mul_f32 v30, v205, v30
  v_mul_f32 v31, v205, v31
  v_mul_f32 v32, v205, v32
  v_mul_f32 v33, v205, v33
  v_mul_f32 v34, v205, v34
  v_mul_f32 v35, v205, v35
  v_mul_f32 v36, v205, v36
  v_mul_f32 v37, v205, v37
  v_mul_f32 v38, v205, v38
  v_mul_f32 v39, v205, v39
  v_mul_f32 v40, v205, v40
  v_mul_f32 v41, v205, v41
  v_mul_f32 v42, v205, v42
  v_mul_f32 v43, v205, v43
  v_mul_f32 v44, v205, v44
  v_mul_f32 v45, v205, v45
  v_mul_f32 v46, v205, v46
  v_mul_f32 v47, v205, v47
  v_mul_f32 v48, v205, v48
  v_mul_f32 v49, v205, v49
  v_mul_f32 v50, v205, v50
  v_mul_f32 v51, v205, v51
  v_mul_f32 v52, v205, v52
  v_mul_f32 v53, v205, v53
  v_mul_f32 v54, v205, v54
  v_mul_f32 v55, v205, v55
  v_mul_f32 v56, v205, v56
  v_mul_f32 v57, v205, v57
  v_mul_f32 v58, v205, v58
  v_mul_f32 v59, v205, v59
  v_mul_f32 v60, v205, v60
  v_mul_f32 v61, v205, v61
  v_mul_f32 v62, v205, v62
  v_mul_f32 v63, v205, v63
  v_mul_f32 v232, v205, v234
  v_mul_f32 v233, v205, v235
  v_sub_f32 v96, v96, v204
  v_sub_f32 v64, v64, v204
  v_sub_f32 v80, v80, v204
  v_sub_f32 v97, v97, v204
  v_sub_f32 v65, v65, v204
  v_sub_f32 v81, v81, v204
  v_sub_f32 v98, v98, v204
  v_sub_f32 v66, v66, v204
  v_sub_f32 v82, v82, v204
  v_sub_f32 v99, v99, v204
  v_sub_f32 v67, v67, v204
  v_sub_f32 v83, v83, v204
  v_sub_f32 v100, v100, v204
  v_sub_f32 v68, v68, v204
  v_sub_f32 v84, v84, v204
  v_sub_f32 v101, v101, v204
  v_sub_f32 v69, v69, v204
  v_sub_f32 v85, v85, v204
  v_sub_f32 v102, v102, v204
  v_sub_f32 v70, v70, v204
  v_sub_f32 v86, v86, v204
  v_sub_f32 v103, v103, v204
  v_sub_f32 v71, v71, v204
  v_sub_f32 v87, v87, v204
  v_sub_f32 v104, v104, v204
  v_sub_f32 v72, v72, v204
  v_sub_f32 v88, v88, v204
  v_sub_f32 v105, v105, v204
  v_sub_f32 v73, v73, v204
  v_sub_f32 v89, v89, v204
  v_sub_f32 v106, v106, v204
  v_sub_f32 v74, v74, v204
  v_sub_f32 v90, v90, v204
  v_sub_f32 v107, v107, v204
  v_sub_f32 v75, v75, v204
  v_sub_f32 v91, v91, v204
  v_sub_f32 v108, v108, v204
  v_sub_f32 v76, v76, v204
  v_sub_f32 v92, v92, v204
  v_sub_f32 v109, v109, v204
  v_sub_f32 v77, v77, v204
  v_sub_f32 v93, v93, v204
  v_sub_f32 v110, v110, v204
  v_sub_f32 v78, v78, v204
  v_sub_f32 v94, v94, v204
  v_sub_f32 v111, v111, v204
  v_sub_f32 v79, v79, v204
  v_sub_f32 v95, v95, v204
  v_exp_f32 v204, v64
  v_exp_f32 v205, v65
  v_exp_f32 v206, v66
  v_exp_f32 v207, v67
  v_add_f32 v232, v232, v204
  v_add_f32 v233, v233, v205
  v_cvt_pk_bf16_f32 v144, v204, v205
  v_exp_f32 v208, v68
  v_exp_f32 v209, v69
  v_add_f32 v232, v232, v206
  v_add_f32 v233, v233, v207
  v_cvt_pk_bf16_f32 v145, v206, v207
  v_exp_f32 v210, v70
  v_exp_f32 v211, v71
  v_add_f32 v232, v232, v208
  v_add_f32 v233, v233, v209
  v_cvt_pk_bf16_f32 v146, v208, v209
  v_exp_f32 v204, v72
  v_exp_f32 v205, v73
  v_add_f32 v232, v232, v210
  v_add_f32 v233, v233, v211
  v_cvt_pk_bf16_f32 v147, v210, v211
  v_exp_f32 v206, v74
  v_exp_f32 v207, v75
  v_add_f32 v232, v232, v204
  v_add_f32 v233, v233, v205
  v_cvt_pk_bf16_f32 v148, v204, v205
  v_exp_f32 v208, v76
  v_exp_f32 v209, v77
  v_add_f32 v232, v232, v206
  v_add_f32 v233, v233, v207
  v_cvt_pk_bf16_f32 v149, v206, v207
  v_exp_f32 v210, v78
  v_exp_f32 v211, v79
  v_add_f32 v232, v232, v208
  v_add_f32 v233, v233, v209
  v_cvt_pk_bf16_f32 v150, v208, v209
  v_add_f32 v232, v232, v210
  v_add_f32 v233, v233, v211
  v_cvt_pk_bf16_f32 v151, v210, v211
  s_nop 1
  s_branch K1_BACK_2
K1_RARE_31:
  s_nop 15
  s_nop 3
  v_max3_f32 v204, v80, v81, v82
  v_max3_f32 v205, v83, v84, v85
  v_max3_f32 v204, v204, v86, v87
  v_max3_f32 v205, v205, v88, v89
  v_max3_f32 v204, v204, v90, v91
  v_max3_f32 v205, v205, v92, v93
  v_max3_f32 v204, v204, v94, v95
  v_max_f32 v204, v204, v205
  v_mov_b32 v205, v204
  s_nop 1
  v_permlane32_swap_b32 v204, v205
  s_nop 1
  v_max_f32 v204, v204, v205
  v_max_f32 v204, 0, v204
  v_exp_f32 v205, -v204
  s_nop 0
  v_mul_f32 v0, v205, v0
  v_mul_f32 v1, v205, v1
  v_mul_f32 v2, v205, v2
  v_mul_f32 v3, v205, v3
  v_mul_f32 v4, v205, v4
  v_mul_f32 v5, v205, v5
  v_mul_f32 v6, v205, v6
  v_mul_f32 v7, v205, v7
  v_mul_f32 v8, v205, v8
  v_mul_f32 v9, v205, v9
  v_mul_f32 v10, v205, v10
  v_mul_f32 v11, v205, v11
  v_mul_f32 v12, v205, v12
  v_mul_f32 v13, v205, v13
  v_mul_f32 v14, v205, v14
  v_mul_f32 v15, v205, v15
  v_mul_f32 v16, v205, v16
  v_mul_f32 v17, v205, v17
  v_mul_f32 v18, v205, v18
  v_mul_f32 v19, v205, v19
  v_mul_f32 v20, v205, v20
  v_mul_f32 v21, v205, v21
  v_mul_f32 v22, v205, v22
  v_mul_f32 v23, v205, v23
  v_mul_f32 v24, v205, v24
  v_mul_f32 v25, v205, v25
  v_mul_f32 v26, v205, v26
  v_mul_f32 v27, v205, v27
  v_mul_f32 v28, v205, v28
  v_mul_f32 v29, v205, v29
  v_mul_f32 v30, v205, v30
  v_mul_f32 v31, v205, v31
  v_mul_f32 v32, v205, v32
  v_mul_f32 v33, v205, v33
  v_mul_f32 v34, v205, v34
  v_mul_f32 v35, v205, v35
  v_mul_f32 v36, v205, v36
  v_mul_f32 v37, v205, v37
  v_mul_f32 v38, v205, v38
  v_mul_f32 v39, v205, v39
  v_mul_f32 v40, v205, v40
  v_mul_f32 v41, v205, v41
  v_mul_f32 v42, v205, v42
  v_mul_f32 v43, v205, v43
  v_mul_f32 v44, v205, v44
  v_mul_f32 v45, v205, v45
  v_mul_f32 v46, v205, v46
  v_mul_f32 v47, v205, v47
  v_mul_f32 v48, v205, v48
  v_mul_f32 v49, v205, v49
  v_mul_f32 v50, v205, v50
  v_mul_f32 v51, v205, v51
  v_mul_f32 v52, v205, v52
  v_mul_f32 v53, v205, v53
  v_mul_f32 v54, v205, v54
  v_mul_f32 v55, v205, v55
  v_mul_f32 v56, v205, v56
  v_mul_f32 v57, v205, v57
  v_mul_f32 v58, v205, v58
  v_mul_f32 v59, v205, v59
  v_mul_f32 v60, v205, v60
  v_mul_f32 v61, v205, v61
  v_mul_f32 v62, v205, v62
  v_mul_f32 v63, v205, v63
  v_mul_f32 v232, v205, v234
  v_mul_f32 v233, v205, v235
  v_sub_f32 v96, v96, v204
  v_sub_f32 v64, v64, v204
  v_sub_f32 v80, v80, v204
  v_sub_f32 v97, v97, v204
  v_sub_f32 v65, v65, v204
  v_sub_f32 v81, v81, v204
  v_sub_f32 v98, v98, v204
  v_sub_f32 v66, v66, v204
  v_sub_f32 v82, v82, v204
  v_sub_f32 v99, v99, v204
  v_sub_f32 v67, v67, v204
  v_sub_f32 v83, v83, v204
  v_sub_f32 v100, v100, v204
  v_sub_f32 v68, v68, v204
  v_sub_f32 v84, v84, v204
  v_sub_f32 v101, v101, v204
  v_sub_f32 v69, v69, v204
  v_sub_f32 v85, v85, v204
  v_sub_f32 v102, v102, v204
  v_sub_f32 v70, v70, v204
  v_sub_f32 v86, v86, v204
  v_sub_f32 v103, v103, v204
  v_sub_f32 v71, v71, v204
  v_sub_f32 v87, v87, v204
  v_sub_f32 v104, v104, v204
  v_sub_f32 v72, v72, v204
  v_sub_f32 v88, v88, v204
  v_sub_f32 v105, v105, v204
  v_sub_f32 v73, v73, v204
  v_sub_f32 v89, v89, v204
  v_sub_f32 v106, v106, v204
  v_sub_f32 v74, v74, v204
  v_sub_f32 v90, v90, v204
  v_sub_f32 v107, v107, v204
  v_sub_f32 v75, v75, v204
  v_sub_f32 v91, v91, v204
  v_sub_f32 v108, v108, v204
  v_sub_f32 v76, v76, v204
  v_sub_f32 v92, v92, v204
  v_sub_f32 v109, v109, v204
  v_sub_f32 v77, v77, v204
  v_sub_f32 v93, v93, v204
  v_sub_f32 v110, v110, v204
  v_sub_f32 v78, v78, v204
  v_sub_f32 v94, v94, v204
  v_sub_f32 v111, v111, v204
  v_sub_f32 v79, v79, v204
  v_sub_f32 v95, v95, v204
  v_exp_f32 v204, v80
  v_exp_f32 v205, v81
  v_exp_f32 v206, v82
  v_exp_f32 v207, v83
  v_add_f32 v232, v232, v204
  v_add_f32 v233, v233, v205
  v_cvt_pk_bf16_f32 v152, v204, v205
  v_exp_f32 v208, v84
  v_exp_f32 v209, v85
  v_add_f32 v232, v232, v206
  v_add_f32 v233, v233, v207
  v_cvt_pk_bf16_f32 v153, v206, v207
  v_exp_f32 v210, v86
  v_exp_f32 v211, v87
  v_add_f32 v232, v232, v208
  v_add_f32 v233, v233, v209
  v_cvt_pk_bf16_f32 v154, v208, v209
  v_exp_f32 v204, v88
  v_exp_f32 v205, v89
  v_add_f32 v232, v232, v210
  v_add_f32 v233, v233, v211
  v_cvt_pk_bf16_f32 v155, v210, v211
  v_exp_f32 v206, v90
  v_exp_f32 v207, v91
  v_add_f32 v232, v232, v204
  v_add_f32 v233, v233, v205
  v_cvt_pk_bf16_f32 v156, v204, v205
  v_exp_f32 v208, v92
  v_exp_f32 v209, v93
  v_add_f32 v232, v232, v206
  v_add_f32 v233, v233, v207
  v_cvt_pk_bf16_f32 v157, v206, v207
  v_exp_f32 v210, v94
  v_exp_f32 v211, v95
  v_add_f32 v232, v232, v208
  v_add_f32 v233, v233, v209
  v_cvt_pk_bf16_f32 v158, v208, v209
  v_add_f32 v232, v232, v210
  v_add_f32 v233, v233, v211
  v_cvt_pk_bf16_f32 v159, v210, v211
  s_nop 1
  s_branch K1_BACK_31
K1_LOADER:
  v_lshrrev_b32 v10, 4, v220
  v_and_b32 v11, 15, v220
  v_xor_b32 v12, v11, v10
  v_lshlrev_b32 v12, 4, v12
  v_lshl_add_u32 v2, v10, 8, v12
  v_xor_b32 v3, 64, v2
  v_xor_b32 v4, 128, v2
  v_xor_b32 v5, 192, v2
  v_lshlrev_b32 v12, 2, v10
  v_xor_b32 v12, v11, v12
  v_lshlrev_b32 v12, 4, v12
  v_lshl_add_u32 v6, v10, 8, v12
  v_lshl_add_u32 v7, v10, 13, v12
  s_lshl_b32 s51, s29, 8
  s_mov_b32 m0, 47104
  s_add_u32 s49, s51, 458752
  buffer_load_dwordx4 v7, s[16:19], s49 offen  lds
  s_mov_b32 m0, 48128
  s_add_u32 s49, s51, 491520
  buffer_load_dwordx4 v7, s[16:19], s49 offen  lds
  s_mov_b32 m0, 81920
  s_add_u32 s49, s51, 524288
  buffer_load_dwordx4 v7, s[16:19], s49 offen  lds
  s_mov_b32 m0, 82944
  s_add_u32 s49, s51, 557056
  buffer_load_dwordx4 v7, s[16:19], s49 offen  lds
  s_mov_b32 m0, 83968
  s_add_u32 s49, s51, 589824
  buffer_load_dwordx4 v7, s[16:19], s49 offen  lds
  s_mov_b32 m0, 84992
  s_add_u32 s49, s51, 622592
  buffer_load_dwordx4 v7, s[16:19], s49 offen  lds
  s_mov_b32 m0, 86016
  s_add_u32 s49, s51, 655360
  buffer_load_dwordx4 v7, s[16:19], s49 offen  lds
  s_mov_b32 m0, 87040
  s_add_u32 s49, s51, 688128
  buffer_load_dwordx4 v7, s[16:19], s49 offen  lds
  s_mov_b32 m0, 88064
  s_add_u32 s49, s51, 720896
  buffer_load_dwordx4 v7, s[16:19], s49 offen  lds
  s_mov_b32 m0, 89088
  s_add_u32 s49, s51, 753664
  buffer_load_dwordx4 v7, s[16:19], s49 offen  lds
  s_mov_b32 m0, 90112
  s_add_u32 s49, s51, 786432
  buffer_load_dwordx4 v7, s[16:19], s49 offen  lds
  s_mov_b32 m0, 91136
  s_add_u32 s49, s51, 819200
  buffer_load_dwordx4 v7, s[16:19], s49 offen  lds
  s_mov_b32 m0, 92160
  s_add_u32 s49, s51, 851968
  buffer_load_dwordx4 v7, s[16:19], s49 offen  lds
  s_mov_b32 m0, 93184
  s_add_u32 s49, s51, 884736
  buffer_load_dwordx4 v7, s[16:19], s49 offen  lds
  s_mov_b32 m0, 94208
  s_add_u32 s49, s51, 917504
  buffer_load_dwordx4 v7, s[16:19], s49 offen  lds
  s_mov_b32 m0, 95232
  s_add_u32 s49, s51, 950272
  buffer_load_dwordx4 v7, s[16:19], s49 offen  lds
  s_mov_b32 m0, 96256
  s_add_u32 s49, s51, 983040
  buffer_load_dwordx4 v7, s[16:19], s49 offen  lds
  s_mov_b32 m0, 97280
  s_add_u32 s49, s51, 1015808
  buffer_load_dwordx4 v7, s[16:19], s49 offen  lds
  s_waitcnt vmcnt(16)
  s_barrier
  s_mov_b32 m0, 131072
  s_add_u32 s49, s51, 1048576
  buffer_load_dwordx4 v7, s[16:19], s49 offen  lds
  s_mov_b32 m0, 132096
  s_add_u32 s49, s51, 1081344
  buffer_load_dwordx4 v7, s[16:19], s49 offen  lds
  s_mov_b32 m0, 133120
  s_add_u32 s49, s51, 1114112
  buffer_load_dwordx4 v7, s[16:19], s49 offen  lds
  s_mov_b32 m0, 134144
  s_add_u32 s49, s51, 1146880
  buffer_load_dwordx4 v7, s[16:19], s49 offen  lds
  s_mov_b32 m0, 135168
  s_add_u32 s49, s51, 1179648
  buffer_load_dwordx4 v7, s[16:19], s49 offen  lds
  s_mov_b32 m0, 136192
  s_add_u32 s49, s51, 1212416
  buffer_load_dwordx4 v7, s[16:19], s49 offen  lds
  s_mov_b32 m0, 137216
  s_add_u32 s49, s51, 1245184
  buffer_load_dwordx4 v7, s[16:19], s49 offen  lds
  s_mov_b32 m0, 138240
  s_add_u32 s49, s51, 1277952
  buffer_load_dwordx4 v7, s[16:19], s49 offen  lds
  s_mov_b32 m0, 139264
  s_add_u32 s49, s51, 1310720
  buffer_load_dwordx4 v7, s[16:19], s49 offen  lds
  s_mov_b32 m0, 140288
  s_add_u32 s49, s51, 1343488
  buffer_load_dwordx4 v7, s[16:19], s49 offen  lds
  s_mov_b32 m0, 141312
  s_add_u32 s49, s51, 1376256
  buffer_load_dwordx4 v7, s[16:19], s49 offen  lds
  s_mov_b32 m0, 142336
  s_add_u32 s49, s51, 1409024
  buffer_load_dwordx4 v7, s[16:19], s49 offen  lds
  s_mov_b32 m0, 143360
  s_add_u32 s49, s51, 1441792
  buffer_load_dwordx4 v7, s[16:19], s49 offen  lds
  s_mov_b32 m0, 144384
  s_add_u32 s49, s51, 1474560
  buffer_load_dwordx4 v7, s[16:19], s49 offen  lds
  s_mov_b32 m0, 145408
  s_add_u32 s49, s51, 1507328
  buffer_load_dwordx4 v7, s[16:19], s49 offen  lds
  s_mov_b32 m0, 146432
  s_add_u32 s49, s51, 1540096
  buffer_load_dwordx4 v7, s[16:19], s49 offen  lds
  s_waitcnt vmcnt(16)
  s_barrier
  s_mov_b32 m0, 16384
  s_add_u32 s49, s51, 1572864
  buffer_load_dwordx4 v7, s[16:19], s49 offen  lds
  s_mov_b32 m0, 17408
  s_add_u32 s49, s51, 1605632
  buffer_load_dwordx4 v7, s[16:19], s49 offen  lds
  s_mov_b32 m0, 18432
  s_add_u32 s49, s51, 1638400
  buffer_load_dwordx4 v7, s[16:19], s49 offen  lds
  s_mov_b32 m0, 19456
  s_add_u32 s49, s51, 1671168
  buffer_load_dwordx4 v7, s[16:19], s49 offen  lds
  s_mov_b32 m0, 20480
  s_add_u32 s49, s51, 1703936
  buffer_load_dwordx4 v7, s[16:19], s49 offen  lds
  s_mov_b32 m0, 21504
  s_add_u32 s49, s51, 1736704
  buffer_load_dwordx4 v7, s[16:19], s49 offen  lds
  s_mov_b32 m0, 22528
  s_add_u32 s49, s51, 1769472
  buffer_load_dwordx4 v7, s[16:19], s49 offen  lds
  s_mov_b32 m0, 23552
  s_add_u32 s49, s51, 1802240
  buffer_load_dwordx4 v7, s[16:19], s49 offen  lds
  s_mov_b32 m0, 24576
  s_add_u32 s49, s51, 1835008
  buffer_load_dwordx4 v7, s[16:19], s49 offen  lds
  s_mov_b32 m0, 25600
  s_add_u32 s49, s51, 1867776
  buffer_load_dwordx4 v7, s[16:19], s49 offen  lds
  s_mov_b32 m0, 26624
  s_add_u32 s49, s51, 1900544
  buffer_load_dwordx4 v7, s[16:19], s49 offen  lds
  s_mov_b32 m0, 27648
  s_add_u32 s49, s51, 1933312
  buffer_load_dwordx4 v7, s[16:19], s49 offen  lds
  s_mov_b32 m0, 28672
  s_add_u32 s49, s51, 1966080
  buffer_load_dwordx4 v7, s[16:19], s49 offen  lds
  s_mov_b32 m0, 29696
  s_add_u32 s49, s51, 1998848
  buffer_load_dwordx4 v7, s[16:19], s49 offen  lds
  s_mov_b32 m0, 30720
  s_add_u32 s49, s51, 2031616
  buffer_load_dwordx4 v7, s[16:19], s49 offen  lds
  s_mov_b32 m0, 31744
  s_add_u32 s49, s51, 2064384
  buffer_load_dwordx4 v7, s[16:19], s49 offen  lds
  s_waitcnt vmcnt(16)
  s_barrier
  s_mov_b32 m0, 65536
  s_add_u32 s49, s51, 2097152
  buffer_load_dwordx4 v7, s[16:19], s49 offen  lds
  s_mov_b32 m0, 66560
  s_add_u32 s49, s51, 2129920
  buffer_load_dwordx4 v7, s[16:19], s49 offen  lds
  s_mov_b32 m0, 67584
  s_add_u32 s49, s51, 2162688
  buffer_load_dwordx4 v7, s[16:19], s49 offen  lds
  s_mov_b32 m0, 68608
  s_add_u32 s49, s51, 2195456
  buffer_load_dwordx4 v7, s[16:19], s49 offen  lds
  s_mov_b32 m0, 69632
  s_add_u32 s49, s51, 2228224
  buffer_load_dwordx4 v7, s[16:19], s49 offen  lds
  s_mov_b32 m0, 70656
  s_add_u32 s49, s51, 2260992
  buffer_load_dwordx4 v7, s[16:19], s49 offen  lds
  s_mov_b32 m0, 71680
  s_add_u32 s49, s51, 2293760
  buffer_load_dwordx4 v7, s[16:19], s49 offen  lds
  s_mov_b32 m0, 72704
  s_add_u32 s49, s51, 2326528
  buffer_load_dwordx4 v7, s[16:19], s49 offen  lds
  s_mov_b32 m0, 73728
  s_add_u32 s49, s51, 2359296
  buffer_load_dwordx4 v7, s[16:19], s49 offen  lds
  s_mov_b32 m0, 74752
  s_add_u32 s49, s51, 2392064
  buffer_load_dwordx4 v7, s[16:19], s49 offen  lds
  s_mov_b32 m0, 75776
  s_add_u32 s49, s51, 2424832
  buffer_load_dwordx4 v7, s[16:19], s49 offen  lds
  s_mov_b32 m0, 76800
  s_add_u32 s49, s51, 2457600
  buffer_load_dwordx4 v7, s[16:19], s49 offen  lds
  s_mov_b32 m0, 77824
  s_add_u32 s49, s51, 2490368
  buffer_load_dwordx4 v7, s[16:19], s49 offen  lds
  s_mov_b32 m0, 78848
  s_add_u32 s49, s51, 2523136
  buffer_load_dwordx4 v7, s[16:19], s49 offen  lds
  s_mov_b32 m0, 79872
  s_add_u32 s49, s51, 2555904
  buffer_load_dwordx4 v7, s[16:19], s49 offen  lds
  s_mov_b32 m0, 80896
  s_add_u32 s49, s51, 2588672
  buffer_load_dwordx4 v7, s[16:19], s49 offen  lds
  s_waitcnt vmcnt(16)
  s_barrier
  s_mov_b32 m0, 114688
  s_add_u32 s49, s51, 2621440
  buffer_load_dwordx4 v7, s[16:19], s49 offen  lds
  s_mov_b32 m0, 115712
  s_add_u32 s49, s51, 2654208
  buffer_load_dwordx4 v7, s[16:19], s49 offen  lds
  s_mov_b32 m0, 116736
  s_add_u32 s49, s51, 2686976
  buffer_load_dwordx4 v7, s[16:19], s49 offen  lds
  s_mov_b32 m0, 117760
  s_add_u32 s49, s51, 2719744
  buffer_load_dwordx4 v7, s[16:19], s49 offen  lds
  s_mov_b32 m0, 118784
  s_add_u32 s49, s51, 2752512
  buffer_load_dwordx4 v7, s[16:19], s49 offen  lds
  s_mov_b32 m0, 119808
  s_add_u32 s49, s51, 2785280
  buffer_load_dwordx4 v7, s[16:19], s49 offen  lds
  s_mov_b32 m0, 120832
  s_add_u32 s49, s51, 2818048
  buffer_load_dwordx4 v7, s[16:19], s49 offen  lds
  s_mov_b32 m0, 121856
  s_add_u32 s49, s51, 2850816
  buffer_load_dwordx4 v7, s[16:19], s49 offen  lds
  s_mov_b32 m0, 122880
  s_add_u32 s49, s51, 2883584
  buffer_load_dwordx4 v7, s[16:19], s49 offen  lds
  s_mov_b32 m0, 123904
  s_add_u32 s49, s51, 2916352
  buffer_load_dwordx4 v7, s[16:19], s49 offen  lds
  s_mov_b32 m0, 124928
  s_add_u32 s49, s51, 2949120
  buffer_load_dwordx4 v7, s[16:19], s49 offen  lds
  s_mov_b32 m0, 125952
  s_add_u32 s49, s51, 2981888
  buffer_load_dwordx4 v7, s[16:19], s49 offen  lds
  s_mov_b32 m0, 126976
  s_add_u32 s49, s51, 3014656
  buffer_load_dwordx4 v7, s[16:19], s49 offen  lds
  s_mov_b32 m0, 128000
  s_add_u32 s49, s51, 3047424
  buffer_load_dwordx4 v7, s[16:19], s49 offen  lds
  s_mov_b32 m0, 129024
  s_add_u32 s49, s51, 3080192
  buffer_load_dwordx4 v7, s[16:19], s49 offen  lds
  s_mov_b32 m0, 130048
  s_add_u32 s49, s51, 3112960
  buffer_load_dwordx4 v7, s[16:19], s49 offen  lds
  s_waitcnt vmcnt(16)
  s_barrier
  s_mov_b32 m0, 0
  s_add_u32 s49, s51, 3145728
  buffer_load_dwordx4 v7, s[16:19], s49 offen  lds
  s_mov_b32 m0, 1024
  s_add_u32 s49, s51, 3178496
  buffer_load_dwordx4 v7, s[16:19], s49 offen  lds
  s_mov_b32 m0, 2048
  s_add_u32 s49, s51, 3211264
  buffer_load_dwordx4 v7, s[16:19], s49 offen  lds
  s_mov_b32 m0, 3072
  s_add_u32 s49, s51, 3244032
  buffer_load_dwordx4 v7, s[16:19], s49 offen  lds
  s_mov_b32 m0, 4096
  s_add_u32 s49, s51, 3276800
  buffer_load_dwordx4 v7, s[16:19], s49 offen  lds
  s_mov_b32 m0, 5120
  s_add_u32 s49, s51, 3309568
  buffer_load_dwordx4 v7, s[16:19], s49 offen  lds
  s_mov_b32 m0, 6144
  s_add_u32 s49, s51, 3342336
  buffer_load_dwordx4 v7, s[16:19], s49 offen  lds
  s_mov_b32 m0, 7168
  s_add_u32 s49, s51, 3375104
  buffer_load_dwordx4 v7, s[16:19], s49 offen  lds
  s_mov_b32 m0, 8192
  s_add_u32 s49, s51, 3407872
  buffer_load_dwordx4 v7, s[16:19], s49 offen  lds
  s_mov_b32 m0, 9216
  s_add_u32 s49, s51, 3440640
  buffer_load_dwordx4 v7, s[16:19], s49 offen  lds
  s_mov_b32 m0, 10240
  s_add_u32 s49, s51, 3473408
  buffer_load_dwordx4 v7, s[16:19], s49 offen  lds
  s_mov_b32 m0, 11264
  s_add_u32 s49, s51, 3506176
  buffer_load_dwordx4 v7, s[16:19], s49 offen  lds
  s_mov_b32 m0, 12288
  s_add_u32 s49, s51, 3538944
  buffer_load_dwordx4 v7, s[16:19], s49 offen  lds
  s_mov_b32 m0, 13312
  s_add_u32 s49, s51, 3571712
  buffer_load_dwordx4 v7, s[16:19], s49 offen  lds
  s_mov_b32 m0, 14336
  s_add_u32 s49, s51, 3604480
  buffer_load_dwordx4 v7, s[16:19], s49 offen  lds
  s_mov_b32 m0, 15360
  s_add_u32 s49, s51, 3637248
  buffer_load_dwordx4 v7, s[16:19], s49 offen  lds
  s_waitcnt vmcnt(16)
  s_barrier
  s_mov_b32 m0, 49152
  s_add_u32 s49, s51, 3670016
  buffer_load_dwordx4 v7, s[16:19], s49 offen  lds
  s_mov_b32 m0, 50176
  s_add_u32 s49, s51, 3702784
  buffer_load_dwordx4 v7, s[16:19], s49 offen  lds
  s_mov_b32 m0, 51200
  s_add_u32 s49, s51, 3735552
  buffer_load_dwordx4 v7, s[16:19], s49 offen  lds
  s_mov_b32 m0, 52224
  s_add_u32 s49, s51, 3768320
  buffer_load_dwordx4 v7, s[16:19], s49 offen  lds
  s_mov_b32 m0, 53248
  s_add_u32 s49, s51, 3801088
  buffer_load_dwordx4 v7, s[16:19], s49 offen  lds
  s_mov_b32 m0, 54272
  s_add_u32 s49, s51, 3833856
  buffer_load_dwordx4 v7, s[16:19], s49 offen  lds
  s_mov_b32 m0, 55296
  s_add_u32 s49, s51, 3866624
  buffer_load_dwordx4 v7, s[16:19], s49 offen  lds
  s_mov_b32 m0, 56320
  s_add_u32 s49, s51, 3899392
  buffer_load_dwordx4 v7, s[16:19], s49 offen  lds
  s_mov_b32 m0, 57344
  s_add_u32 s49, s51, 3932160
  buffer_load_dwordx4 v7, s[16:19], s49 offen  lds
  s_mov_b32 m0, 58368
  s_add_u32 s49, s51, 3964928
  buffer_load_dwordx4 v7, s[16:19], s49 offen  lds
  s_mov_b32 m0, 59392
  s_add_u32 s49, s51, 3997696
  buffer_load_dwordx4 v7, s[16:19], s49 offen  lds
  s_mov_b32 m0, 60416
  s_add_u32 s49, s51, 4030464
  buffer_load_dwordx4 v7, s[16:19], s49 offen  lds
  s_mov_b32 m0, 61440
  s_add_u32 s49, s51, 4063232
  buffer_load_dwordx4 v7, s[16:19], s49 offen  lds
  s_mov_b32 m0, 62464
  s_add_u32 s49, s51, 4096000
  buffer_load_dwordx4 v7, s[16:19], s49 offen  lds
  s_mov_b32 m0, 63488
  s_add_u32 s49, s51, 4128768
  buffer_load_dwordx4 v7, s[16:19], s49 offen  lds
  s_mov_b32 m0, 64512
  s_add_u32 s49, s51, 4161536
  buffer_load_dwordx4 v7, s[16:19], s49 offen  lds
  s_waitcnt vmcnt(16)
  s_barrier
  s_mov_b32 m0, 81920
  s_mov_b32 s49, 0
  buffer_load_dwordx4 v2, s[8:11], s49 offen offset:0 nt lds
  buffer_load_dwordx4 v3, s[8:11], s49 offen offset:1024 nt lds
  buffer_load_dwordx4 v4, s[8:11], s49 offen offset:2048 nt lds
  buffer_load_dwordx4 v5, s[8:11], s49 offen offset:3072 nt lds
  s_mov_b32 m0, 86016
  s_mov_b32 s49, 4096
  buffer_load_dwordx4 v2, s[8:11], s49 offen offset:0 nt lds
  buffer_load_dwordx4 v3, s[8:11], s49 offen offset:1024 nt lds
  buffer_load_dwordx4 v4, s[8:11], s49 offen offset:2048 nt lds
  buffer_load_dwordx4 v5, s[8:11], s49 offen offset:3072 nt lds
  s_mov_b32 m0, 90112
  s_mov_b32 s49, 8192
  buffer_load_dwordx4 v2, s[8:11], s49 offen offset:0 nt lds
  buffer_load_dwordx4 v3, s[8:11], s49 offen offset:1024 nt lds
  buffer_load_dwordx4 v4, s[8:11], s49 offen offset:2048 nt lds
  buffer_load_dwordx4 v5, s[8:11], s49 offen offset:3072 nt lds
  s_mov_b32 m0, 94208
  s_mov_b32 s49, 12288
  buffer_load_dwordx4 v2, s[8:11], s49 offen offset:0 nt lds
  buffer_load_dwordx4 v3, s[8:11], s49 offen offset:1024 nt lds
  buffer_load_dwordx4 v4, s[8:11], s49 offen offset:2048 nt lds
  buffer_load_dwordx4 v5, s[8:11], s49 offen offset:3072 nt lds
  s_waitcnt vmcnt(16)
  s_barrier
  s_mov_b32 m0, 98304
  s_mov_b32 s49, 0
  buffer_load_dwordx4 v6, s[12:15], s49 offen offset:0 nt lds
  buffer_load_dwordx4 v6, s[12:15], s49 offen offset:1024 nt lds
  buffer_load_dwordx4 v6, s[12:15], s49 offen offset:2048 nt lds
  buffer_load_dwordx4 v6, s[12:15], s49 offen offset:3072 nt lds
  s_mov_b32 m0, 102400
  s_mov_b32 s49, 4096
  buffer_load_dwordx4 v6, s[12:15], s49 offen offset:0 nt lds
  buffer_load_dwordx4 v6, s[12:15], s49 offen offset:1024 nt lds
  buffer_load_dwordx4 v6, s[12:15], s49 offen offset:2048 nt lds
  buffer_load_dwordx4 v6, s[12:15], s49 offen offset:3072 nt lds
  s_mov_b32 m0, 106496
  s_mov_b32 s49, 8192
  buffer_load_dwordx4 v6, s[12:15], s49 offen offset:0 nt lds
  buffer_load_dwordx4 v6, s[12:15], s49 offen offset:1024 nt lds
  buffer_load_dwordx4 v6, s[12:15], s49 offen offset:2048 nt lds
  buffer_load_dwordx4 v6, s[12:15], s49 offen offset:3072 nt lds
  s_mov_b32 m0, 110592
  s_mov_b32 s49, 12288
  buffer_load_dwordx4 v6, s[12:15], s49 offen offset:0 nt lds
  buffer_load_dwordx4 v6, s[12:15], s49 offen offset:1024 nt lds
  buffer_load_dwordx4 v6, s[12:15], s49 offen offset:2048 nt lds
  buffer_load_dwordx4 v6, s[12:15], s49 offen offset:3072 nt lds
  s_mov_b32 m0, 114688
  s_mov_b32 s49, 16384
  buffer_load_dwordx4 v2, s[8:11], s49 offen offset:0 nt lds
  buffer_load_dwordx4 v3, s[8:11], s49 offen offset:1024 nt lds
  buffer_load_dwordx4 v4, s[8:11], s49 offen offset:2048 nt lds
  buffer_load_dwordx4 v5, s[8:11], s49 offen offset:3072 nt lds
  s_mov_b32 m0, 118784
  s_mov_b32 s49, 20480
  buffer_load_dwordx4 v2, s[8:11], s49 offen offset:0 nt lds
  buffer_load_dwordx4 v3, s[8:11], s49 offen offset:1024 nt lds
  buffer_load_dwordx4 v4, s[8:11], s49 offen offset:2048 nt lds
  buffer_load_dwordx4 v5, s[8:11], s49 offen offset:3072 nt lds
  s_mov_b32 m0, 122880
  s_mov_b32 s49, 24576
  buffer_load_dwordx4 v2, s[8:11], s49 offen offset:0 nt lds
  buffer_load_dwordx4 v3, s[8:11], s49 offen offset:1024 nt lds
  buffer_load_dwordx4 v4, s[8:11], s49 offen offset:2048 nt lds
  buffer_load_dwordx4 v5, s[8:11], s49 offen offset:3072 nt lds
  s_mov_b32 m0, 126976
  s_mov_b32 s49, 28672
  buffer_load_dwordx4 v2, s[8:11], s49 offen offset:0 nt lds
  buffer_load_dwordx4 v3, s[8:11], s49 offen offset:1024 nt lds
  buffer_load_dwordx4 v4, s[8:11], s49 offen offset:2048 nt lds
  buffer_load_dwordx4 v5, s[8:11], s49 offen offset:3072 nt lds
  v_and_b32 v10, 0x13, v220
  v_bfe_u32 v11, v220, 2, 1
  v_bfe_u32 v12, v220, 3, 1
  v_lshl_add_u32 v10, v11, 3, v10
  v_lshl_add_u32 v10, v12, 2, v10
  v_lshlrev_b32 v10, 1, v10
  v_lshrrev_b32 v11, 5, v220
  v_lshl_add_u32 v10, v11, 13, v10
  v_add_u32 v11, 4096, v10
  v_lshlrev_b32 v12, 4, v220
  s_lshl_b32 s48, s2, 14
  s_lshl_b32 s50, s2, 10
  s_add_u32 s50, s50, 16777216
  s_waitcnt vmcnt(32)
  s_barrier
  s_mov_b32 m0, 131072
  s_mov_b32 s49, 16384
  buffer_load_dwordx4 v6, s[12:15], s49 offen offset:0 nt lds
  buffer_load_dwordx4 v6, s[12:15], s49 offen offset:1024 nt lds
  buffer_load_dwordx4 v6, s[12:15], s49 offen offset:2048 nt lds
  buffer_load_dwordx4 v6, s[12:15], s49 offen offset:3072 nt lds
  s_mov_b32 m0, 135168
  s_mov_b32 s49, 20480
  buffer_load_dwordx4 v6, s[12:15], s49 offen offset:0 nt lds
  buffer_load_dwordx4 v6, s[12:15], s49 offen offset:1024 nt lds
  buffer_load_dwordx4 v6, s[12:15], s49 offen offset:2048 nt lds
  buffer_load_dwordx4 v6, s[12:15], s49 offen offset:3072 nt lds
  s_mov_b32 m0, 139264
  s_mov_b32 s49, 24576
  buffer_load_dwordx4 v6, s[12:15], s49 offen offset:0 nt lds
  buffer_load_dwordx4 v6, s[12:15], s49 offen offset:1024 nt lds
  buffer_load_dwordx4 v6, s[12:15], s49 offen offset:2048 nt lds
  buffer_load_dwordx4 v6, s[12:15], s49 offen offset:3072 nt lds
  s_mov_b32 m0, 143360
  s_mov_b32 s49, 28672
  buffer_load_dwordx4 v6, s[12:15], s49 offen offset:0 nt lds
  buffer_load_dwordx4 v6, s[12:15], s49 offen offset:1024 nt lds
  buffer_load_dwordx4 v6, s[12:15], s49 offen offset:2048 nt lds
  buffer_load_dwordx4 v6, s[12:15], s49 offen offset:3072 nt lds
  s_mov_b32 m0, 147456
  s_mov_b32 s49, 32768
  buffer_load_dwordx4 v2, s[8:11], s49 offen offset:0 nt lds
  buffer_load_dwordx4 v3, s[8:11], s49 offen offset:1024 nt lds
  buffer_load_dwordx4 v4, s[8:11], s49 offen offset:2048 nt lds
  buffer_load_dwordx4 v5, s[8:11], s49 offen offset:3072 nt lds
  s_mov_b32 m0, 151552
  s_mov_b32 s49, 36864
  buffer_load_dwordx4 v2, s[8:11], s49 offen offset:0 nt lds
  buffer_load_dwordx4 v3, s[8:11], s49 offen offset:1024 nt lds
  buffer_load_dwordx4 v4, s[8:11], s49 offen offset:2048 nt lds
  buffer_load_dwordx4 v5, s[8:11], s49 offen offset:3072 nt lds
  s_mov_b32 m0, 155648
  s_mov_b32 s49, 40960
  buffer_load_dwordx4 v2, s[8:11], s49 offen offset:0 nt lds
  buffer_load_dwordx4 v3, s[8:11], s49 offen offset:1024 nt lds
  buffer_load_dwordx4 v4, s[8:11], s49 offen offset:2048 nt lds
  buffer_load_dwordx4 v5, s[8:11], s49 offen offset:3072 nt lds
  s_mov_b32 m0, 159744
  s_mov_b32 s49, 45056
  buffer_load_dwordx4 v2, s[8:11], s49 offen offset:0 nt lds
  buffer_load_dwordx4 v3, s[8:11], s49 offen offset:1024 nt lds
  buffer_load_dwordx4 v4, s[8:11], s49 offen offset:2048 nt lds
  buffer_load_dwordx4 v5, s[8:11], s49 offen offset:3072 nt lds
  s_waitcnt vmcnt(32)
  s_barrier
  s_add_u32 s49, s48, 0
  buffer_load_ushort v16, v10, s[24:27], s49 offen offset:0
  buffer_load_ushort v17, v10, s[24:27], s49 offen offset:1024
  buffer_load_ushort v18, v10, s[24:27], s49 offen offset:2048
  buffer_load_ushort v19, v10, s[24:27], s49 offen offset:3072
  buffer_load_ushort v20, v11, s[24:27], s49 offen offset:0
  buffer_load_ushort v21, v11, s[24:27], s49 offen offset:1024
  buffer_load_ushort v22, v11, s[24:27], s49 offen offset:2048
  buffer_load_ushort v23, v11, s[24:27], s49 offen offset:3072
  s_add_u32 s49, s48, 64
  buffer_load_ushort v24, v10, s[24:27], s49 offen offset:0
  buffer_load_ushort v25, v10, s[24:27], s49 offen offset:1024
  buffer_load_ushort v26, v10, s[24:27], s49 offen offset:2048
  buffer_load_ushort v27, v10, s[24:27], s49 offen offset:3072
  buffer_load_ushort v28, v11, s[24:27], s49 offen offset:0
  buffer_load_ushort v29, v11, s[24:27], s49 offen offset:1024
  buffer_load_ushort v30, v11, s[24:27], s49 offen offset:2048
  buffer_load_ushort v31, v11, s[24:27], s49 offen offset:3072
  s_mov_b32 m0, 0
  s_mov_b32 s49, 32768
  buffer_load_dwordx4 v6, s[12:15], s49 offen offset:0 nt lds
  buffer_load_dwordx4 v6, s[12:15], s49 offen offset:1024 nt lds
  buffer_load_dwordx4 v6, s[12:15], s49 offen offset:2048 nt lds
  buffer_load_dwordx4 v6, s[12:15], s49 offen offset:3072 nt lds
  s_mov_b32 m0, 4096
  s_mov_b32 s49, 36864
  buffer_load_dwordx4 v6, s[12:15], s49 offen offset:0 nt lds
  buffer_load_dwordx4 v6, s[12:15], s49 offen offset:1024 nt lds
  buffer_load_dwordx4 v6, s[12:15], s49 offen offset:2048 nt lds
  buffer_load_dwordx4 v6, s[12:15], s49 offen offset:3072 nt lds
  s_mov_b32 m0, 8192
  s_mov_b32 s49, 40960
  buffer_load_dwordx4 v6, s[12:15], s49 offen offset:0 nt lds
  buffer_load_dwordx4 v6, s[12:15], s49 offen offset:1024 nt lds
  buffer_load_dwordx4 v6, s[12:15], s49 offen offset:2048 nt lds
  buffer_load_dwordx4 v6, s[12:15], s49 offen offset:3072 nt lds
  s_mov_b32 m0, 12288
  s_mov_b32 s49, 45056
  buffer_load_dwordx4 v6, s[12:15], s49 offen offset:0 nt lds
  buffer_load_dwordx4 v6, s[12:15], s49 offen offset:1024 nt lds
  buffer_load_dwordx4 v6, s[12:15], s49 offen offset:2048 nt lds
  buffer_load_dwordx4 v6, s[12:15], s49 offen offset:3072 nt lds
  s_mov_b32 m0, 16384
  s_mov_b32 s49, 49152
  buffer_load_dwordx4 v2, s[8:11], s49 offen offset:0 nt lds
  buffer_load_dwordx4 v3, s[8:11], s49 offen offset:1024 nt lds
  buffer_load_dwordx4 v4, s[8:11], s49 offen offset:2048 nt lds
  buffer_load_dwordx4 v5, s[8:11], s49 offen offset:3072 nt lds
  s_mov_b32 m0, 20480
  s_mov_b32 s49, 53248
  buffer_load_dwordx4 v2, s[8:11], s49 offen offset:0 nt lds
  buffer_load_dwordx4 v3, s[8:11], s49 offen offset:1024 nt lds
  buffer_load_dwordx4 v4, s[8:11], s49 offen offset:2048 nt lds
  buffer_load_dwordx4 v5, s[8:11], s49 offen offset:3072 nt lds
  s_mov_b32 m0, 24576
  s_mov_b32 s49, 57344
  buffer_load_dwordx4 v2, s[8:11], s49 offen offset:0 nt lds
  buffer_load_dwordx4 v3, s[8:11], s49 offen offset:1024 nt lds
  buffer_load_dwordx4 v4, s[8:11], s49 offen offset:2048 nt lds
  buffer_load_dwordx4 v5, s[8:11], s49 offen offset:3072 nt lds
  s_mov_b32 m0, 28672
  s_mov_b32 s49, 61440
  buffer_load_dwordx4 v2, s[8:11], s49 offen offset:0 nt lds
  buffer_load_dwordx4 v3, s[8:11], s49 offen offset:1024 nt lds
  buffer_load_dwordx4 v4, s[8:11], s49 offen offset:2048 nt lds
  buffer_load_dwordx4 v5, s[8:11], s49 offen offset:3072 nt lds
  s_waitcnt vmcnt(48)
  s_barrier
  s_add_u32 s49, s48, 128
  buffer_load_ushort v32, v10, s[24:27], s49 offen offset:0
  buffer_load_ushort v33, v10, s[24:27], s49 offen offset:1024
  buffer_load_ushort v34, v10, s[24:27], s49 offen offset:2048
  buffer_load_ushort v35, v10, s[24:27], s49 offen offset:3072
  buffer_load_ushort v36, v11, s[24:27], s49 offen offset:0
  buffer_load_ushort v37, v11, s[24:27], s49 offen offset:1024
  buffer_load_ushort v38, v11, s[24:27], s49 offen offset:2048
  buffer_load_ushort v39, v11, s[24:27], s49 offen offset:3072
  s_add_u32 s49, s48, 192
  buffer_load_ushort v40, v10, s[24:27], s49 offen offset:0
  buffer_load_ushort v41, v10, s[24:27], s49 offen offset:1024
  buffer_load_ushort v42, v10, s[24:27], s49 offen offset:2048
  buffer_load_ushort v43, v10, s[24:27], s49 offen offset:3072
  buffer_load_ushort v44, v11, s[24:27], s49 offen offset:0
  buffer_load_ushort v45, v11, s[24:27], s49 offen offset:1024
  buffer_load_ushort v46, v11, s[24:27], s49 offen offset:2048
  buffer_load_ushort v47, v11, s[24:27], s49 offen offset:3072
  s_mov_b32 m0, 32768
  s_mov_b32 s49, 49152
  buffer_load_dwordx4 v6, s[12:15], s49 offen offset:0 nt lds
  buffer_load_dwordx4 v6, s[12:15], s49 offen offset:1024 nt lds
  buffer_load_dwordx4 v6, s[12:15], s49 offen offset:2048 nt lds
  buffer_load_dwordx4 v6, s[12:15], s49 offen offset:3072 nt lds
  s_mov_b32 m0, 36864
  s_mov_b32 s49, 53248
  buffer_load_dwordx4 v6, s[12:15], s49 offen offset:0 nt lds
  buffer_load_dwordx4 v6, s[12:15], s49 offen offset:1024 nt lds
  buffer_load_dwordx4 v6, s[12:15], s49 offen offset:2048 nt lds
  buffer_load_dwordx4 v6, s[12:15], s49 offen offset:3072 nt lds
  s_mov_b32 m0, 40960
  s_mov_b32 s49, 57344
  buffer_load_dwordx4 v6, s[12:15], s49 offen offset:0 nt lds
  buffer_load_dwordx4 v6, s[12:15], s49 offen offset:1024 nt lds
  buffer_load_dwordx4 v6, s[12:15], s49 offen offset:2048 nt lds
  buffer_load_dwordx4 v6, s[12:15], s49 offen offset:3072 nt lds
  s_mov_b32 m0, 45056
  s_mov_b32 s49, 61440
  buffer_load_dwordx4 v6, s[12:15], s49 offen offset:0 nt lds
  buffer_load_dwordx4 v6, s[12:15], s49 offen offset:1024 nt lds
  buffer_load_dwordx4 v6, s[12:15], s49 offen offset:2048 nt lds
  buffer_load_dwordx4 v6, s[12:15], s49 offen offset:3072 nt lds
  s_mov_b32 m0, 49152
  s_mov_b32 s49, 65536
  buffer_load_dwordx4 v2, s[8:11], s49 offen offset:0 nt lds
  buffer_load_dwordx4 v3, s[8:11], s49 offen offset:1024 nt lds
  buffer_load_dwordx4 v4, s[8:11], s49 offen offset:2048 nt lds
  buffer_load_dwordx4 v5, s[8:11], s49 offen offset:3072 nt lds
  s_mov_b32 m0, 53248
  s_mov_b32 s49, 69632
  buffer_load_dwordx4 v2, s[8:11], s49 offen offset:0 nt lds
  buffer_load_dwordx4 v3, s[8:11], s49 offen offset:1024 nt lds
  buffer_load_dwordx4 v4, s[8:11], s49 offen offset:2048 nt lds
  buffer_load_dwordx4 v5, s[8:11], s49 offen offset:3072 nt lds
  s_mov_b32 m0, 57344
  s_mov_b32 s49, 73728
  buffer_load_dwordx4 v2, s[8:11], s49 offen offset:0 nt lds
  buffer_load_dwordx4 v3, s[8:11], s49 offen offset:1024 nt lds
  buffer_load_dwordx4 v4, s[8:11], s49 offen offset:2048 nt lds
  buffer_load_dwordx4 v5, s[8:11], s49 offen offset:3072 nt lds
  s_mov_b32 m0, 61440
  s_mov_b32 s49, 77824
  buffer_load_dwordx4 v2, s[8:11], s49 offen offset:0 nt lds
  buffer_load_dwordx4 v3, s[8:11], s49 offen offset:1024 nt lds
  buffer_load_dwordx4 v4, s[8:11], s49 offen offset:2048 nt lds
  buffer_load_dwordx4 v5, s[8:11], s49 offen offset:3072 nt lds
  s_waitcnt vmcnt(48)
  s_barrier
  v_lshl_or_b32 v160, v17, 16, v16
  v_lshl_or_b32 v161, v19, 16, v18
  v_lshl_or_b32 v162, v21, 16, v20
  v_lshl_or_b32 v163, v23, 16, v22
  s_add_u32 s49, s50, 0
  buffer_store_dwordx4 v[160:163], v12, s[20:23], s49 offen sc0 sc1
  v_lshl_or_b32 v164, v25, 16, v24
  v_lshl_or_b32 v165, v27, 16, v26
  v_lshl_or_b32 v166, v29, 16, v28
  v_lshl_or_b32 v167, v31, 16, v30
  s_add_u32 s49, s50, 262144
  buffer_store_dwordx4 v[164:167], v12, s[20:23], s49 offen sc0 sc1
  s_add_u32 s49, s48, 256
  buffer_load_ushort v48, v10, s[24:27], s49 offen offset:0
  buffer_load_ushort v49, v10, s[24:27], s49 offen offset:1024
  buffer_load_ushort v50, v10, s[24:27], s49 offen offset:2048
  buffer_load_ushort v51, v10, s[24:27], s49 offen offset:3072
  buffer_load_ushort v52, v11, s[24:27], s49 offen offset:0
  buffer_load_ushort v53, v11, s[24:27], s49 offen offset:1024
  buffer_load_ushort v54, v11, s[24:27], s49 offen offset:2048
  buffer_load_ushort v55, v11, s[24:27], s49 offen offset:3072
  s_add_u32 s49, s48, 320
  buffer_load_ushort v56, v10, s[24:27], s49 offen offset:0
  buffer_load_ushort v57, v10, s[24:27], s49 offen offset:1024
  buffer_load_ushort v58, v10, s[24:27], s49 offen offset:2048
  buffer_load_ushort v59, v10, s[24:27], s49 offen offset:3072
  buffer_load_ushort v60, v11, s[24:27], s49 offen offset:0
  buffer_load_ushort v61, v11, s[24:27], s49 offen offset:1024
  buffer_load_ushort v62, v11, s[24:27], s49 offen offset:2048
  buffer_load_ushort v63, v11, s[24:27], s49 offen offset:3072
  s_mov_b32 m0, 65536
  s_mov_b32 s49, 65536
  buffer_load_dwordx4 v6, s[12:15], s49 offen offset:0 nt lds
  buffer_load_dwordx4 v6, s[12:15], s49 offen offset:1024 nt lds
  buffer_load_dwordx4 v6, s[12:15], s49 offen offset:2048 nt lds
  buffer_load_dwordx4 v6, s[12:15], s49 offen offset:3072 nt lds
  s_mov_b32 m0, 69632
  s_mov_b32 s49, 69632
  buffer_load_dwordx4 v6, s[12:15], s49 offen offset:0 nt lds
  buffer_load_dwordx4 v6, s[12:15], s49 offen offset:1024 nt lds
  buffer_load_dwordx4 v6, s[12:15], s49 offen offset:2048 nt lds
  buffer_load_dwordx4 v6, s[12:15], s49 offen offset:3072 nt lds
  s_mov_b32 m0, 73728
  s_mov_b32 s49, 73728
  buffer_load_dwordx4 v6, s[12:15], s49 offen offset:0 nt lds
  buffer_load_dwordx4 v6, s[12:15], s49 offen offset:1024 nt lds
  buffer_load_dwordx4 v6, s[12:15], s49 offen offset:2048 nt lds
  buffer_load_dwordx4 v6, s[12:15], s49 offen offset:3072 nt lds
  s_mov_b32 m0, 77824
  s_mov_b32 s49, 77824
  buffer_load_dwordx4 v6, s[12:15], s49 offen offset:0 nt lds
  buffer_load_dwordx4 v6, s[12:15], s49 offen offset:1024 nt lds
  buffer_load_dwordx4 v6, s[12:15], s49 offen offset:2048 nt lds
  buffer_load_dwordx4 v6, s[12:15], s49 offen offset:3072 nt lds
  s_mov_b32 m0, 81920
  s_mov_b32 s49, 81920
  buffer_load_dwordx4 v2, s[8:11], s49 offen offset:0 nt lds
  buffer_load_dwordx4 v3, s[8:11], s49 offen offset:1024 nt lds
  buffer_load_dwordx4 v4, s[8:11], s49 offen offset:2048 nt lds
  buffer_load_dwordx4 v5, s[8:11], s49 offen offset:3072 nt lds
  s_mov_b32 m0, 86016
  s_mov_b32 s49, 86016
  buffer_load_dwordx4 v2, s[8:11], s49 offen offset:0 nt lds
  buffer_load_dwordx4 v3, s[8:11], s49 offen offset:1024 nt lds
  buffer_load_dwordx4 v4, s[8:11], s49 offen offset:2048 nt lds
  buffer_load_dwordx4 v5, s[8:11], s49 offen offset:3072 nt lds
  s_mov_b32 m0, 90112
  s_mov_b32 s49, 90112
  buffer_load_dwordx4 v2, s[8:11], s49 offen offset:0 nt lds
  buffer_load_dwordx4 v3, s[8:11], s49 offen offset:1024 nt lds
  buffer_load_dwordx4 v4, s[8:11], s49 offen offset:2048 nt lds
  buffer_load_dwordx4 v5, s[8:11], s49 offen offset:3072 nt lds
  s_mov_b32 m0, 94208
  s_mov_b32 s49, 94208
  buffer_load_dwordx4 v2, s[8:11], s49 offen offset:0 nt lds
  buffer_load_dwordx4 v3, s[8:11], s49 offen offset:1024 nt lds
  buffer_load_dwordx4 v4, s[8:11], s49 offen offset:2048 nt lds
  buffer_load_dwordx4 v5, s[8:11], s49 offen offset:3072 nt lds
  s_waitcnt vmcnt(50)
  s_barrier
  v_lshl_or_b32 v168, v33, 16, v32
  v_lshl_or_b32 v169, v35, 16, v34
  v_lshl_or_b32 v170, v37, 16, v36
  v_lshl_or_b32 v171, v39, 16, v38
  s_add_u32 s49, s50, 524288
  buffer_store_dwordx4 v[168:171], v12, s[20:23], s49 offen sc0 sc1
  v_lshl_or_b32 v172, v41, 16, v40
  v_lshl_or_b32 v173, v43, 16, v42
  v_lshl_or_b32 v174, v45, 16, v44
  v_lshl_or_b32 v175, v47, 16, v46
  s_add_u32 s49, s50, 786432
  buffer_store_dwordx4 v[172:175], v12, s[20:23], s49 offen sc0 sc1
  s_add_u32 s49, s48, 384
  buffer_load_ushort v64, v10, s[24:27], s49 offen offset:0
  buffer_load_ushort v65, v10, s[24:27], s49 offen offset:1024
  buffer_load_ushort v66, v10, s[24:27], s49 offen offset:2048
  buffer_load_ushort v67, v10, s[24:27], s49 offen offset:3072
  buffer_load_ushort v68, v11, s[24:27], s49 offen offset:0
  buffer_load_ushort v69, v11, s[24:27], s49 offen offset:1024
  buffer_load_ushort v70, v11, s[24:27], s49 offen offset:2048
  buffer_load_ushort v71, v11, s[24:27], s49 offen offset:3072
  s_add_u32 s49, s48, 448
  buffer_load_ushort v72, v10, s[24:27], s49 offen offset:0
  buffer_load_ushort v73, v10, s[24:27], s49 offen offset:1024
  buffer_load_ushort v74, v10, s[24:27], s49 offen offset:2048
  buffer_load_ushort v75, v10, s[24:27], s49 offen offset:3072
  buffer_load_ushort v76, v11, s[24:27], s49 offen offset:0
  buffer_load_ushort v77, v11, s[24:27], s49 offen offset:1024
  buffer_load_ushort v78, v11, s[24:27], s49 offen offset:2048
  buffer_load_ushort v79, v11, s[24:27], s49 offen offset:3072
  s_mov_b32 m0, 98304
  s_mov_b32 s49, 81920
  buffer_load_dwordx4 v6, s[12:15], s49 offen offset:0 nt lds
  buffer_load_dwordx4 v6, s[12:15], s49 offen offset:1024 nt lds
  buffer_load_dwordx4 v6, s[12:15], s49 offen offset:2048 nt lds
  buffer_load_dwordx4 v6, s[12:15], s49 offen offset:3072 nt lds
  s_mov_b32 m0, 102400
  s_mov_b32 s49, 86016
  buffer_load_dwordx4 v6, s[12:15], s49 offen offset:0 nt lds
  buffer_load_dwordx4 v6, s[12:15], s49 offen offset:1024 nt lds
  buffer_load_dwordx4 v6, s[12:15], s49 offen offset:2048 nt lds
  buffer_load_dwordx4 v6, s[12:15], s49 offen offset:3072 nt lds
  s_mov_b32 m0, 106496
  s_mov_b32 s49, 90112
  buffer_load_dwordx4 v6, s[12:15], s49 offen offset:0 nt lds
  buffer_load_dwordx4 v6, s[12:15], s49 offen offset:1024 nt lds
  buffer_load_dwordx4 v6, s[12:15], s49 offen offset:2048 nt lds
  buffer_load_dwordx4 v6, s[12:15], s49 offen offset:3072 nt lds
  s_mov_b32 m0, 110592
  s_mov_b32 s49, 94208
  buffer_load_dwordx4 v6, s[12:15], s49 offen offset:0 nt lds
  buffer_load_dwordx4 v6, s[12:15], s49 offen offset:1024 nt lds
  buffer_load_dwordx4 v6, s[12:15], s49 offen offset:2048 nt lds
  buffer_load_dwordx4 v6, s[12:15], s49 offen offset:3072 nt lds
  s_mov_b32 m0, 114688
  s_mov_b32 s49, 98304
  buffer_load_dwordx4 v2, s[8:11], s49 offen offset:0 nt lds
  buffer_load_dwordx4 v3, s[8:11], s49 offen offset:1024 nt lds
  buffer_load_dwordx4 v4, s[8:11], s49 offen offset:2048 nt lds
  buffer_load_dwordx4 v5, s[8:11], s49 offen offset:3072 nt lds
  s_mov_b32 m0, 118784
  s_mov_b32 s49, 102400
  buffer_load_dwordx4 v2, s[8:11], s49 offen offset:0 nt lds
  buffer_load_dwordx4 v3, s[8:11], s49 offen offset:1024 nt lds
  buffer_load_dwordx4 v4, s[8:11], s49 offen offset:2048 nt lds
  buffer_load_dwordx4 v5, s[8:11], s49 offen offset:3072 nt lds
  s_mov_b32 m0, 122880
  s_mov_b32 s49, 106496
  buffer_load_dwordx4 v2, s[8:11], s49 offen offset:0 nt lds
  buffer_load_dwordx4 v3, s[8:11], s49 offen offset:1024 nt lds
  buffer_load_dwordx4 v4, s[8:11], s49 offen offset:2048 nt lds
  buffer_load_dwordx4 v5, s[8:11], s49 offen offset:3072 nt lds
  s_mov_b32 m0, 126976
  s_mov_b32 s49, 110592
  buffer_load_dwordx4 v2, s[8:11], s49 offen offset:0 nt lds
  buffer_load_dwordx4 v3, s[8:11], s49 offen offset:1024 nt lds
  buffer_load_dwordx4 v4, s[8:11], s49 offen offset:2048 nt lds
  buffer_load_dwordx4 v5, s[8:11], s49 offen offset:3072 nt lds
  s_waitcnt vmcnt(50)
  s_barrier
  v_lshl_or_b32 v176, v49, 16, v48
  v_lshl_or_b32 v177, v51, 16, v50
  v_lshl_or_b32 v178, v53, 16, v52
  v_lshl_or_b32 v179, v55, 16, v54
  s_add_u32 s49, s50, 1048576
  buffer_store_dwordx4 v[176:179], v12, s[20:23], s49 offen sc0 sc1
  v_lshl_or_b32 v180, v57, 16, v56
  v_lshl_or_b32 v181, v59, 16, v58
  v_lshl_or_b32 v182, v61, 16, v60
  v_lshl_or_b32 v183, v63, 16, v62
  s_add_u32 s49, s50, 1310720
  buffer_store_dwordx4 v[180:183], v12, s[20:23], s49 offen sc0 sc1
  s_add_u32 s49, s48, 512
  buffer_load_ushort v80, v10, s[24:27], s49 offen offset:0
  buffer_load_ushort v81, v10, s[24:27], s49 offen offset:1024
  buffer_load_ushort v82, v10, s[24:27], s49 offen offset:2048
  buffer_load_ushort v83, v10, s[24:27], s49 offen offset:3072
  buffer_load_ushort v84, v11, s[24:27], s49 offen offset:0
  buffer_load_ushort v85, v11, s[24:27], s49 offen offset:1024
  buffer_load_ushort v86, v11, s[24:27], s49 offen offset:2048
  buffer_load_ushort v87, v11, s[24:27], s49 offen offset:3072
  s_add_u32 s49, s48, 576
  buffer_load_ushort v88, v10, s[24:27], s49 offen offset:0
  buffer_load_ushort v89, v10, s[24:27], s49 offen offset:1024
  buffer_load_ushort v90, v10, s[24:27], s49 offen offset:2048
  buffer_load_ushort v91, v10, s[24:27], s49 offen offset:3072
  buffer_load_ushort v92, v11, s[24:27], s49 offen offset:0
  buffer_load_ushort v93, v11, s[24:27], s49 offen offset:1024
  buffer_load_ushort v94, v11, s[24:27], s49 offen offset:2048
  buffer_load_ushort v95, v11, s[24:27], s49 offen offset:3072
  s_mov_b32 m0, 131072
  s_mov_b32 s49, 98304
  buffer_load_dwordx4 v6, s[12:15], s49 offen offset:0 nt lds
  buffer_load_dwordx4 v6, s[12:15], s49 offen offset:1024 nt lds
  buffer_load_dwordx4 v6, s[12:15], s49 offen offset:2048 nt lds
  buffer_load_dwordx4 v6, s[12:15], s49 offen offset:3072 nt lds
  s_mov_b32 m0, 135168
  s_mov_b32 s49, 102400
  buffer_load_dwordx4 v6, s[12:15], s49 offen offset:0 nt lds
  buffer_load_dwordx4 v6, s[12:15], s49 offen offset:1024 nt lds
  buffer_load_dwordx4 v6, s[12:15], s49 offen offset:2048 nt lds
  buffer_load_dwordx4 v6, s[12:15], s49 offen offset:3072 nt lds
  s_mov_b32 m0, 139264
  s_mov_b32 s49, 106496
  buffer_load_dwordx4 v6, s[12:15], s49 offen offset:0 nt lds
  buffer_load_dwordx4 v6, s[12:15], s49 offen offset:1024 nt lds
  buffer_load_dwordx4 v6, s[12:15], s49 offen offset:2048 nt lds
  buffer_load_dwordx4 v6, s[12:15], s49 offen offset:3072 nt lds
  s_mov_b32 m0, 143360
  s_mov_b32 s49, 110592
  buffer_load_dwordx4 v6, s[12:15], s49 offen offset:0 nt lds
  buffer_load_dwordx4 v6, s[12:15], s49 offen offset:1024 nt lds
  buffer_load_dwordx4 v6, s[12:15], s49 offen offset:2048 nt lds
  buffer_load_dwordx4 v6, s[12:15], s49 offen offset:3072 nt lds
  s_mov_b32 m0, 147456
  s_mov_b32 s49, 114688
  buffer_load_dwordx4 v2, s[8:11], s49 offen offset:0 nt lds
  buffer_load_dwordx4 v3, s[8:11], s49 offen offset:1024 nt lds
  buffer_load_dwordx4 v4, s[8:11], s49 offen offset:2048 nt lds
  buffer_load_dwordx4 v5, s[8:11], s49 offen offset:3072 nt lds
  s_mov_b32 m0, 151552
  s_mov_b32 s49, 118784
  buffer_load_dwordx4 v2, s[8:11], s49 offen offset:0 nt lds
  buffer_load_dwordx4 v3, s[8:11], s49 offen offset:1024 nt lds
  buffer_load_dwordx4 v4, s[8:11], s49 offen offset:2048 nt lds
  buffer_load_dwordx4 v5, s[8:11], s49 offen offset:3072 nt lds
  s_mov_b32 m0, 155648
  s_mov_b32 s49, 122880
  buffer_load_dwordx4 v2, s[8:11], s49 offen offset:0 nt lds
  buffer_load_dwordx4 v3, s[8:11], s49 offen offset:1024 nt lds
  buffer_load_dwordx4 v4, s[8:11], s49 offen offset:2048 nt lds
  buffer_load_dwordx4 v5, s[8:11], s49 offen offset:3072 nt lds
  s_mov_b32 m0, 159744
  s_mov_b32 s49, 126976
  buffer_load_dwordx4 v2, s[8:11], s49 offen offset:0 nt lds
  buffer_load_dwordx4 v3, s[8:11], s49 offen offset:1024 nt lds
  buffer_load_dwordx4 v4, s[8:11], s49 offen offset:2048 nt lds
  buffer_load_dwordx4 v5, s[8:11], s49 offen offset:3072 nt lds
  s_waitcnt vmcnt(50)
  s_barrier
  v_lshl_or_b32 v184, v65, 16, v64
  v_lshl_or_b32 v185, v67, 16, v66
  v_lshl_or_b32 v186, v69, 16, v68
  v_lshl_or_b32 v187, v71, 16, v70
  s_add_u32 s49, s50, 1572864
  buffer_store_dwordx4 v[184:187], v12, s[20:23], s49 offen sc0 sc1
  v_lshl_or_b32 v188, v73, 16, v72
  v_lshl_or_b32 v189, v75, 16, v74
  v_lshl_or_b32 v190, v77, 16, v76
  v_lshl_or_b32 v191, v79, 16, v78
  s_add_u32 s49, s50, 1835008
  buffer_store_dwordx4 v[188:191], v12, s[20:23], s49 offen sc0 sc1
  s_add_u32 s49, s48, 640
  buffer_load_ushort v96, v10, s[24:27], s49 offen offset:0
  buffer_load_ushort v97, v10, s[24:27], s49 offen offset:1024
  buffer_load_ushort v98, v10, s[24:27], s49 offen offset:2048
  buffer_load_ushort v99, v10, s[24:27], s49 offen offset:3072
  buffer_load_ushort v100, v11, s[24:27], s49 offen offset:0
  buffer_load_ushort v101, v11, s[24:27], s49 offen offset:1024
  buffer_load_ushort v102, v11, s[24:27], s49 offen offset:2048
  buffer_load_ushort v103, v11, s[24:27], s49 offen offset:3072
  s_add_u32 s49, s48, 704
  buffer_load_ushort v104, v10, s[24:27], s49 offen offset:0
  buffer_load_ushort v105, v10, s[24:27], s49 offen offset:1024
  buffer_load_ushort v106, v10, s[24:27], s49 offen offset:2048
  buffer_load_ushort v107, v10, s[24:27], s49 offen offset:3072
  buffer_load_ushort v108, v11, s[24:27], s49 offen offset:0
  buffer_load_ushort v109, v11, s[24:27], s49 offen offset:1024
  buffer_load_ushort v110, v11, s[24:27], s49 offen offset:2048
  buffer_load_ushort v111, v11, s[24:27], s49 offen offset:3072
  s_mov_b32 m0, 0
  s_mov_b32 s49, 114688
  buffer_load_dwordx4 v6, s[12:15], s49 offen offset:0 nt lds
  buffer_load_dwordx4 v6, s[12:15], s49 offen offset:1024 nt lds
  buffer_load_dwordx4 v6, s[12:15], s49 offen offset:2048 nt lds
  buffer_load_dwordx4 v6, s[12:15], s49 offen offset:3072 nt lds
  s_mov_b32 m0, 4096
  s_mov_b32 s49, 118784
  buffer_load_dwordx4 v6, s[12:15], s49 offen offset:0 nt lds
  buffer_load_dwordx4 v6, s[12:15], s49 offen offset:1024 nt lds
  buffer_load_dwordx4 v6, s[12:15], s49 offen offset:2048 nt lds
  buffer_load_dwordx4 v6, s[12:15], s49 offen offset:3072 nt lds
  s_mov_b32 m0, 8192
  s_mov_b32 s49, 122880
  buffer_load_dwordx4 v6, s[12:15], s49 offen offset:0 nt lds
  buffer_load_dwordx4 v6, s[12:15], s49 offen offset:1024 nt lds
  buffer_load_dwordx4 v6, s[12:15], s49 offen offset:2048 nt lds
  buffer_load_dwordx4 v6, s[12:15], s49 offen offset:3072 nt lds
  s_mov_b32 m0, 12288
  s_mov_b32 s49, 126976
  buffer_load_dwordx4 v6, s[12:15], s49 offen offset:0 nt lds
  buffer_load_dwordx4 v6, s[12:15], s49 offen offset:1024 nt lds
  buffer_load_dwordx4 v6, s[12:15], s49 offen offset:2048 nt lds
  buffer_load_dwordx4 v6, s[12:15], s49 offen offset:3072 nt lds
  s_mov_b32 m0, 16384
  s_mov_b32 s49, 131072
  buffer_load_dwordx4 v2, s[8:11], s49 offen offset:0 nt lds
  buffer_load_dwordx4 v3, s[8:11], s49 offen offset:1024 nt lds
  buffer_load_dwordx4 v4, s[8:11], s49 offen offset:2048 nt lds
  buffer_load_dwordx4 v5, s[8:11], s49 offen offset:3072 nt lds
  s_mov_b32 m0, 20480
  s_mov_b32 s49, 135168
  buffer_load_dwordx4 v2, s[8:11], s49 offen offset:0 nt lds
  buffer_load_dwordx4 v3, s[8:11], s49 offen offset:1024 nt lds
  buffer_load_dwordx4 v4, s[8:11], s49 offen offset:2048 nt lds
  buffer_load_dwordx4 v5, s[8:11], s49 offen offset:3072 nt lds
  s_mov_b32 m0, 24576
  s_mov_b32 s49, 139264
  buffer_load_dwordx4 v2, s[8:11], s49 offen offset:0 nt lds
  buffer_load_dwordx4 v3, s[8:11], s49 offen offset:1024 nt lds
  buffer_load_dwordx4 v4, s[8:11], s49 offen offset:2048 nt lds
  buffer_load_dwordx4 v5, s[8:11], s49 offen offset:3072 nt lds
  s_mov_b32 m0, 28672
  s_mov_b32 s49, 143360
  buffer_load_dwordx4 v2, s[8:11], s49 offen offset:0 nt lds
  buffer_load_dwordx4 v3, s[8:11], s49 offen offset:1024 nt lds
  buffer_load_dwordx4 v4, s[8:11], s49 offen offset:2048 nt lds
  buffer_load_dwordx4 v5, s[8:11], s49 offen offset:3072 nt lds
  s_waitcnt vmcnt(50)
  s_barrier
  v_lshl_or_b32 v192, v81, 16, v80
  v_lshl_or_b32 v193, v83, 16, v82
  v_lshl_or_b32 v194, v85, 16, v84
  v_lshl_or_b32 v195, v87, 16, v86
  s_add_u32 s49, s50, 2097152
  buffer_store_dwordx4 v[192:195], v12, s[20:23], s49 offen sc0 sc1
  v_lshl_or_b32 v196, v89, 16, v88
  v_lshl_or_b32 v197, v91, 16, v90
  v_lshl_or_b32 v198, v93, 16, v92
  v_lshl_or_b32 v199, v95, 16, v94
  s_add_u32 s49, s50, 2359296
  buffer_store_dwordx4 v[196:199], v12, s[20:23], s49 offen sc0 sc1
  s_add_u32 s49, s48, 768
  buffer_load_ushort v112, v10, s[24:27], s49 offen offset:0
  buffer_load_ushort v113, v10, s[24:27], s49 offen offset:1024
  buffer_load_ushort v114, v10, s[24:27], s49 offen offset:2048
  buffer_load_ushort v115, v10, s[24:27], s49 offen offset:3072
  buffer_load_ushort v116, v11, s[24:27], s49 offen offset:0
  buffer_load_ushort v117, v11, s[24:27], s49 offen offset:1024
  buffer_load_ushort v118, v11, s[24:27], s49 offen offset:2048
  buffer_load_ushort v119, v11, s[24:27], s49 offen offset:3072
  s_add_u32 s49, s48, 832
  buffer_load_ushort v120, v10, s[24:27], s49 offen offset:0
  buffer_load_ushort v121, v10, s[24:27], s49 offen offset:1024
  buffer_load_ushort v122, v10, s[24:27], s49 offen offset:2048
  buffer_load_ushort v123, v10, s[24:27], s49 offen offset:3072
  buffer_load_ushort v124, v11, s[24:27], s49 offen offset:0
  buffer_load_ushort v125, v11, s[24:27], s49 offen offset:1024
  buffer_load_ushort v126, v11, s[24:27], s49 offen offset:2048
  buffer_load_ushort v127, v11, s[24:27], s49 offen offset:3072
  s_mov_b32 m0, 32768
  s_mov_b32 s49, 131072
  buffer_load_dwordx4 v6, s[12:15], s49 offen offset:0 nt lds
  buffer_load_dwordx4 v6, s[12:15], s49 offen offset:1024 nt lds
  buffer_load_dwordx4 v6, s[12:15], s49 offen offset:2048 nt lds
  buffer_load_dwordx4 v6, s[12:15], s49 offen offset:3072 nt lds
  s_mov_b32 m0, 36864
  s_mov_b32 s49, 135168
  buffer_load_dwordx4 v6, s[12:15], s49 offen offset:0 nt lds
  buffer_load_dwordx4 v6, s[12:15], s49 offen offset:1024 nt lds
  buffer_load_dwordx4 v6, s[12:15], s49 offen offset:2048 nt lds
  buffer_load_dwordx4 v6, s[12:15], s49 offen offset:3072 nt lds
  s_mov_b32 m0, 40960
  s_mov_b32 s49, 139264
  buffer_load_dwordx4 v6, s[12:15], s49 offen offset:0 nt lds
  buffer_load_dwordx4 v6, s[12:15], s49 offen offset:1024 nt lds
  buffer_load_dwordx4 v6, s[12:15], s49 offen offset:2048 nt lds
  buffer_load_dwordx4 v6, s[12:15], s49 offen offset:3072 nt lds
  s_mov_b32 m0, 45056
  s_mov_b32 s49, 143360
  buffer_load_dwordx4 v6, s[12:15], s49 offen offset:0 nt lds
  buffer_load_dwordx4 v6, s[12:15], s49 offen offset:1024 nt lds
  buffer_load_dwordx4 v6, s[12:15], s49 offen offset:2048 nt lds
  buffer_load_dwordx4 v6, s[12:15], s49 offen offset:3072 nt lds
  s_mov_b32 m0, 49152
  s_mov_b32 s49, 147456
  buffer_load_dwordx4 v2, s[8:11], s49 offen offset:0 nt lds
  buffer_load_dwordx4 v3, s[8:11], s49 offen offset:1024 nt lds
  buffer_load_dwordx4 v4, s[8:11], s49 offen offset:2048 nt lds
  buffer_load_dwordx4 v5, s[8:11], s49 offen offset:3072 nt lds
  s_mov_b32 m0, 53248
  s_mov_b32 s49, 151552
  buffer_load_dwordx4 v2, s[8:11], s49 offen offset:0 nt lds
  buffer_load_dwordx4 v3, s[8:11], s49 offen offset:1024 nt lds
  buffer_load_dwordx4 v4, s[8:11], s49 offen offset:2048 nt lds
  buffer_load_dwordx4 v5, s[8:11], s49 offen offset:3072 nt lds
  s_mov_b32 m0, 57344
  s_mov_b32 s49, 155648
  buffer_load_dwordx4 v2, s[8:11], s49 offen offset:0 nt lds
  buffer_load_dwordx4 v3, s[8:11], s49 offen offset:1024 nt lds
  buffer_load_dwordx4 v4, s[8:11], s49 offen offset:2048 nt lds
  buffer_load_dwordx4 v5, s[8:11], s49 offen offset:3072 nt lds
  s_mov_b32 m0, 61440
  s_mov_b32 s49, 159744
  buffer_load_dwordx4 v2, s[8:11], s49 offen offset:0 nt lds
  buffer_load_dwordx4 v3, s[8:11], s49 offen offset:1024 nt lds
  buffer_load_dwordx4 v4, s[8:11], s49 offen offset:2048 nt lds
  buffer_load_dwordx4 v5, s[8:11], s49 offen offset:3072 nt lds
  s_waitcnt vmcnt(50)
  s_barrier
  v_lshl_or_b32 v200, v97, 16, v96
  v_lshl_or_b32 v201, v99, 16, v98
  v_lshl_or_b32 v202, v101, 16, v100
  v_lshl_or_b32 v203, v103, 16, v102
  s_add_u32 s49, s50, 2621440
  buffer_store_dwordx4 v[200:203], v12, s[20:23], s49 offen sc0 sc1
  v_lshl_or_b32 v204, v105, 16, v104
  v_lshl_or_b32 v205, v107, 16, v106
  v_lshl_or_b32 v206, v109, 16, v108
  v_lshl_or_b32 v207, v111, 16, v110
  s_add_u32 s49, s50, 2883584
  buffer_store_dwordx4 v[204:207], v12, s[20:23], s49 offen sc0 sc1
  s_add_u32 s49, s48, 896
  buffer_load_ushort v128, v10, s[24:27], s49 offen offset:0
  buffer_load_ushort v129, v10, s[24:27], s49 offen offset:1024
  buffer_load_ushort v130, v10, s[24:27], s49 offen offset:2048
  buffer_load_ushort v131, v10, s[24:27], s49 offen offset:3072
  buffer_load_ushort v132, v11, s[24:27], s49 offen offset:0
  buffer_load_ushort v133, v11, s[24:27], s49 offen offset:1024
  buffer_load_ushort v134, v11, s[24:27], s49 offen offset:2048
  buffer_load_ushort v135, v11, s[24:27], s49 offen offset:3072
  s_add_u32 s49, s48, 960
  buffer_load_ushort v136, v10, s[24:27], s49 offen offset:0
  buffer_load_ushort v137, v10, s[24:27], s49 offen offset:1024
  buffer_load_ushort v138, v10, s[24:27], s49 offen offset:2048
  buffer_load_ushort v139, v10, s[24:27], s49 offen offset:3072
  buffer_load_ushort v140, v11, s[24:27], s49 offen offset:0
  buffer_load_ushort v141, v11, s[24:27], s49 offen offset:1024
  buffer_load_ushort v142, v11, s[24:27], s49 offen offset:2048
  buffer_load_ushort v143, v11, s[24:27], s49 offen offset:3072
  s_mov_b32 m0, 65536
  s_mov_b32 s49, 147456
  buffer_load_dwordx4 v6, s[12:15], s49 offen offset:0 nt lds
  buffer_load_dwordx4 v6, s[12:15], s49 offen offset:1024 nt lds
  buffer_load_dwordx4 v6, s[12:15], s49 offen offset:2048 nt lds
  buffer_load_dwordx4 v6, s[12:15], s49 offen offset:3072 nt lds
  s_mov_b32 m0, 69632
  s_mov_b32 s49, 151552
  buffer_load_dwordx4 v6, s[12:15], s49 offen offset:0 nt lds
  buffer_load_dwordx4 v6, s[12:15], s49 offen offset:1024 nt lds
  buffer_load_dwordx4 v6, s[12:15], s49 offen offset:2048 nt lds
  buffer_load_dwordx4 v6, s[12:15], s49 offen offset:3072 nt lds
  s_mov_b32 m0, 73728
  s_mov_b32 s49, 155648
  buffer_load_dwordx4 v6, s[12:15], s49 offen offset:0 nt lds
  buffer_load_dwordx4 v6, s[12:15], s49 offen offset:1024 nt lds
  buffer_load_dwordx4 v6, s[12:15], s49 offen offset:2048 nt lds
  buffer_load_dwordx4 v6, s[12:15], s49 offen offset:3072 nt lds
  s_mov_b32 m0, 77824
  s_mov_b32 s49, 159744
  buffer_load_dwordx4 v6, s[12:15], s49 offen offset:0 nt lds
  buffer_load_dwordx4 v6, s[12:15], s49 offen offset:1024 nt lds
  buffer_load_dwordx4 v6, s[12:15], s49 offen offset:2048 nt lds
  buffer_load_dwordx4 v6, s[12:15], s49 offen offset:3072 nt lds
  s_mov_b32 m0, 81920
  s_mov_b32 s49, 163840
  buffer_load_dwordx4 v2, s[8:11], s49 offen offset:0 nt lds
  buffer_load_dwordx4 v3, s[8:11], s49 offen offset:1024 nt lds
  buffer_load_dwordx4 v4, s[8:11], s49 offen offset:2048 nt lds
  buffer_load_dwordx4 v5, s[8:11], s49 offen offset:3072 nt lds
  s_mov_b32 m0, 86016
  s_mov_b32 s49, 167936
  buffer_load_dwordx4 v2, s[8:11], s49 offen offset:0 nt lds
  buffer_load_dwordx4 v3, s[8:11], s49 offen offset:1024 nt lds
  buffer_load_dwordx4 v4, s[8:11], s49 offen offset:2048 nt lds
  buffer_load_dwordx4 v5, s[8:11], s49 offen offset:3072 nt lds
  s_mov_b32 m0, 90112
  s_mov_b32 s49, 172032
  buffer_load_dwordx4 v2, s[8:11], s49 offen offset:0 nt lds
  buffer_load_dwordx4 v3, s[8:11], s49 offen offset:1024 nt lds
  buffer_load_dwordx4 v4, s[8:11], s49 offen offset:2048 nt lds
  buffer_load_dwordx4 v5, s[8:11], s49 offen offset:3072 nt lds
  s_mov_b32 m0, 94208
  s_mov_b32 s49, 176128
  buffer_load_dwordx4 v2, s[8:11], s49 offen offset:0 nt lds
  buffer_load_dwordx4 v3, s[8:11], s49 offen offset:1024 nt lds
  buffer_load_dwordx4 v4, s[8:11], s49 offen offset:2048 nt lds
  buffer_load_dwordx4 v5, s[8:11], s49 offen offset:3072 nt lds
  s_waitcnt vmcnt(50)
  s_barrier
  v_lshl_or_b32 v208, v113, 16, v112
  v_lshl_or_b32 v209, v115, 16, v114
  v_lshl_or_b32 v210, v117, 16, v116
  v_lshl_or_b32 v211, v119, 16, v118
  s_add_u32 s49, s50, 3145728
  buffer_store_dwordx4 v[208:211], v12, s[20:23], s49 offen sc0 sc1
  v_lshl_or_b32 v212, v121, 16, v120
  v_lshl_or_b32 v213, v123, 16, v122
  v_lshl_or_b32 v214, v125, 16, v124
  v_lshl_or_b32 v215, v127, 16, v126
  s_add_u32 s49, s50, 3407872
  buffer_store_dwordx4 v[212:215], v12, s[20:23], s49 offen sc0 sc1
  s_mov_b32 m0, 98304
  s_mov_b32 s49, 163840
  buffer_load_dwordx4 v6, s[12:15], s49 offen offset:0 nt lds
  buffer_load_dwordx4 v6, s[12:15], s49 offen offset:1024 nt lds
  buffer_load_dwordx4 v6, s[12:15], s49 offen offset:2048 nt lds
  buffer_load_dwordx4 v6, s[12:15], s49 offen offset:3072 nt lds
  s_mov_b32 m0, 102400
  s_mov_b32 s49, 167936
  buffer_load_dwordx4 v6, s[12:15], s49 offen offset:0 nt lds
  buffer_load_dwordx4 v6, s[12:15], s49 offen offset:1024 nt lds
  buffer_load_dwordx4 v6, s[12:15], s49 offen offset:2048 nt lds
  buffer_load_dwordx4 v6, s[12:15], s49 offen offset:3072 nt lds
  s_mov_b32 m0, 106496
  s_mov_b32 s49, 172032
  buffer_load_dwordx4 v6, s[12:15], s49 offen offset:0 nt lds
  buffer_load_dwordx4 v6, s[12:15], s49 offen offset:1024 nt lds
  buffer_load_dwordx4 v6, s[12:15], s49 offen offset:2048 nt lds
  buffer_load_dwordx4 v6, s[12:15], s49 offen offset:3072 nt lds
  s_mov_b32 m0, 110592
  s_mov_b32 s49, 176128
  buffer_load_dwordx4 v6, s[12:15], s49 offen offset:0 nt lds
  buffer_load_dwordx4 v6, s[12:15], s49 offen offset:1024 nt lds
  buffer_load_dwordx4 v6, s[12:15], s49 offen offset:2048 nt lds
  buffer_load_dwordx4 v6, s[12:15], s49 offen offset:3072 nt lds
  s_mov_b32 m0, 114688
  s_mov_b32 s49, 180224
  buffer_load_dwordx4 v2, s[8:11], s49 offen offset:0 nt lds
  buffer_load_dwordx4 v3, s[8:11], s49 offen offset:1024 nt lds
  buffer_load_dwordx4 v4, s[8:11], s49 offen offset:2048 nt lds
  buffer_load_dwordx4 v5, s[8:11], s49 offen offset:3072 nt lds
  s_mov_b32 m0, 118784
  s_mov_b32 s49, 184320
  buffer_load_dwordx4 v2, s[8:11], s49 offen offset:0 nt lds
  buffer_load_dwordx4 v3, s[8:11], s49 offen offset:1024 nt lds
  buffer_load_dwordx4 v4, s[8:11], s49 offen offset:2048 nt lds
  buffer_load_dwordx4 v5, s[8:11], s49 offen offset:3072 nt lds
  s_mov_b32 m0, 122880
  s_mov_b32 s49, 188416
  buffer_load_dwordx4 v2, s[8:11], s49 offen offset:0 nt lds
  buffer_load_dwordx4 v3, s[8:11], s49 offen offset:1024 nt lds
  buffer_load_dwordx4 v4, s[8:11], s49 offen offset:2048 nt lds
  buffer_load_dwordx4 v5, s[8:11], s49 offen offset:3072 nt lds
  s_mov_b32 m0, 126976
  s_mov_b32 s49, 192512
  buffer_load_dwordx4 v2, s[8:11], s49 offen offset:0 nt lds
  buffer_load_dwordx4 v3, s[8:11], s49 offen offset:1024 nt lds
  buffer_load_dwordx4 v4, s[8:11], s49 offen offset:2048 nt lds
  buffer_load_dwordx4 v5, s[8:11], s49 offen offset:3072 nt lds
  s_waitcnt vmcnt(34)
  s_barrier
  v_lshl_or_b32 v216, v129, 16, v128
  v_lshl_or_b32 v217, v131, 16, v130
  v_lshl_or_b32 v218, v133, 16, v132
  v_lshl_or_b32 v219, v135, 16, v134
  s_add_u32 s49, s50, 3670016
  buffer_store_dwordx4 v[216:219], v12, s[20:23], s49 offen sc0 sc1
  v_lshl_or_b32 v220, v137, 16, v136
  v_lshl_or_b32 v221, v139, 16, v138
  v_lshl_or_b32 v222, v141, 16, v140
  v_lshl_or_b32 v223, v143, 16, v142
  s_add_u32 s49, s50, 3932160
  buffer_store_dwordx4 v[220:223], v12, s[20:23], s49 offen sc0 sc1
  s_mov_b32 m0, 131072
  s_mov_b32 s49, 180224
  buffer_load_dwordx4 v6, s[12:15], s49 offen offset:0 nt lds
  buffer_load_dwordx4 v6, s[12:15], s49 offen offset:1024 nt lds
  buffer_load_dwordx4 v6, s[12:15], s49 offen offset:2048 nt lds
  buffer_load_dwordx4 v6, s[12:15], s49 offen offset:3072 nt lds
  s_mov_b32 m0, 135168
  s_mov_b32 s49, 184320
  buffer_load_dwordx4 v6, s[12:15], s49 offen offset:0 nt lds
  buffer_load_dwordx4 v6, s[12:15], s49 offen offset:1024 nt lds
  buffer_load_dwordx4 v6, s[12:15], s49 offen offset:2048 nt lds
  buffer_load_dwordx4 v6, s[12:15], s49 offen offset:3072 nt lds
  s_mov_b32 m0, 139264
  s_mov_b32 s49, 188416
  buffer_load_dwordx4 v6, s[12:15], s49 offen offset:0 nt lds
  buffer_load_dwordx4 v6, s[12:15], s49 offen offset:1024 nt lds
  buffer_load_dwordx4 v6, s[12:15], s49 offen offset:2048 nt lds
  buffer_load_dwordx4 v6, s[12:15], s49 offen offset:3072 nt lds
  s_mov_b32 m0, 143360
  s_mov_b32 s49, 192512
  buffer_load_dwordx4 v6, s[12:15], s49 offen offset:0 nt lds
  buffer_load_dwordx4 v6, s[12:15], s49 offen offset:1024 nt lds
  buffer_load_dwordx4 v6, s[12:15], s49 offen offset:2048 nt lds
  buffer_load_dwordx4 v6, s[12:15], s49 offen offset:3072 nt lds
  s_mov_b32 m0, 147456
  s_mov_b32 s49, 196608
  buffer_load_dwordx4 v2, s[8:11], s49 offen offset:0 nt lds
  buffer_load_dwordx4 v3, s[8:11], s49 offen offset:1024 nt lds
  buffer_load_dwordx4 v4, s[8:11], s49 offen offset:2048 nt lds
  buffer_load_dwordx4 v5, s[8:11], s49 offen offset:3072 nt lds
  s_mov_b32 m0, 151552
  s_mov_b32 s49, 200704
  buffer_load_dwordx4 v2, s[8:11], s49 offen offset:0 nt lds
  buffer_load_dwordx4 v3, s[8:11], s49 offen offset:1024 nt lds
  buffer_load_dwordx4 v4, s[8:11], s49 offen offset:2048 nt lds
  buffer_load_dwordx4 v5, s[8:11], s49 offen offset:3072 nt lds
  s_mov_b32 m0, 155648
  s_mov_b32 s49, 204800
  buffer_load_dwordx4 v2, s[8:11], s49 offen offset:0 nt lds
  buffer_load_dwordx4 v3, s[8:11], s49 offen offset:1024 nt lds
  buffer_load_dwordx4 v4, s[8:11], s49 offen offset:2048 nt lds
  buffer_load_dwordx4 v5, s[8:11], s49 offen offset:3072 nt lds
  s_mov_b32 m0, 159744
  s_mov_b32 s49, 208896
  buffer_load_dwordx4 v2, s[8:11], s49 offen offset:0 nt lds
  buffer_load_dwordx4 v3, s[8:11], s49 offen offset:1024 nt lds
  buffer_load_dwordx4 v4, s[8:11], s49 offen offset:2048 nt lds
  buffer_load_dwordx4 v5, s[8:11], s49 offen offset:3072 nt lds
  s_waitcnt vmcnt(34)
  s_barrier
  s_mov_b32 m0, 0
  s_mov_b32 s49, 196608
  buffer_load_dwordx4 v6, s[12:15], s49 offen offset:0 nt lds
  buffer_load_dwordx4 v6, s[12:15], s49 offen offset:1024 nt lds
  buffer_load_dwordx4 v6, s[12:15], s49 offen offset:2048 nt lds
  buffer_load_dwordx4 v6, s[12:15], s49 offen offset:3072 nt lds
  s_mov_b32 m0, 4096
  s_mov_b32 s49, 200704
  buffer_load_dwordx4 v6, s[12:15], s49 offen offset:0 nt lds
  buffer_load_dwordx4 v6, s[12:15], s49 offen offset:1024 nt lds
  buffer_load_dwordx4 v6, s[12:15], s49 offen offset:2048 nt lds
  buffer_load_dwordx4 v6, s[12:15], s49 offen offset:3072 nt lds
  s_mov_b32 m0, 8192
  s_mov_b32 s49, 204800
  buffer_load_dwordx4 v6, s[12:15], s49 offen offset:0 nt lds
  buffer_load_dwordx4 v6, s[12:15], s49 offen offset:1024 nt lds
  buffer_load_dwordx4 v6, s[12:15], s49 offen offset:2048 nt lds
  buffer_load_dwordx4 v6, s[12:15], s49 offen offset:3072 nt lds
  s_mov_b32 m0, 12288
  s_mov_b32 s49, 208896
  buffer_load_dwordx4 v6, s[12:15], s49 offen offset:0 nt lds
  buffer_load_dwordx4 v6, s[12:15], s49 offen offset:1024 nt lds
  buffer_load_dwordx4 v6, s[12:15], s49 offen offset:2048 nt lds
  buffer_load_dwordx4 v6, s[12:15], s49 offen offset:3072 nt lds
  s_mov_b32 m0, 16384
  s_mov_b32 s49, 212992
  buffer_load_dwordx4 v2, s[8:11], s49 offen offset:0 nt lds
  buffer_load_dwordx4 v3, s[8:11], s49 offen offset:1024 nt lds
  buffer_load_dwordx4 v4, s[8:11], s49 offen offset:2048 nt lds
  buffer_load_dwordx4 v5, s[8:11], s49 offen offset:3072 nt lds
  s_mov_b32 m0, 20480
  s_mov_b32 s49, 217088
  buffer_load_dwordx4 v2, s[8:11], s49 offen offset:0 nt lds
  buffer_load_dwordx4 v3, s[8:11], s49 offen offset:1024 nt lds
  buffer_load_dwordx4 v4, s[8:11], s49 offen offset:2048 nt lds
  buffer_load_dwordx4 v5, s[8:11], s49 offen offset:3072 nt lds
  s_mov_b32 m0, 24576
  s_mov_b32 s49, 221184
  buffer_load_dwordx4 v2, s[8:11], s49 offen offset:0 nt lds
  buffer_load_dwordx4 v3, s[8:11], s49 offen offset:1024 nt lds
  buffer_load_dwordx4 v4, s[8:11], s49 offen offset:2048 nt lds
  buffer_load_dwordx4 v5, s[8:11], s49 offen offset:3072 nt lds
  s_mov_b32 m0, 28672
  s_mov_b32 s49, 225280
  buffer_load_dwordx4 v2, s[8:11], s49 offen offset:0 nt lds
  buffer_load_dwordx4 v3, s[8:11], s49 offen offset:1024 nt lds
  buffer_load_dwordx4 v4, s[8:11], s49 offen offset:2048 nt lds
  buffer_load_dwordx4 v5, s[8:11], s49 offen offset:3072 nt lds
  s_waitcnt vmcnt(32)
  s_barrier
  s_mov_b32 m0, 32768
  s_mov_b32 s49, 212992
  buffer_load_dwordx4 v6, s[12:15], s49 offen offset:0 nt lds
  buffer_load_dwordx4 v6, s[12:15], s49 offen offset:1024 nt lds
  buffer_load_dwordx4 v6, s[12:15], s49 offen offset:2048 nt lds
  buffer_load_dwordx4 v6, s[12:15], s49 offen offset:3072 nt lds
  s_mov_b32 m0, 36864
  s_mov_b32 s49, 217088
  buffer_load_dwordx4 v6, s[12:15], s49 offen offset:0 nt lds
  buffer_load_dwordx4 v6, s[12:15], s49 offen offset:1024 nt lds
  buffer_load_dwordx4 v6, s[12:15], s49 offen offset:2048 nt lds
  buffer_load_dwordx4 v6, s[12:15], s49 offen offset:3072 nt lds
  s_mov_b32 m0, 40960
  s_mov_b32 s49, 221184
  buffer_load_dwordx4 v6, s[12:15], s49 offen offset:0 nt lds
  buffer_load_dwordx4 v6, s[12:15], s49 offen offset:1024 nt lds
  buffer_load_dwordx4 v6, s[12:15], s49 offen offset:2048 nt lds
  buffer_load_dwordx4 v6, s[12:15], s49 offen offset:3072 nt lds
  s_mov_b32 m0, 45056
  s_mov_b32 s49, 225280
  buffer_load_dwordx4 v6, s[12:15], s49 offen offset:0 nt lds
  buffer_load_dwordx4 v6, s[12:15], s49 offen offset:1024 nt lds
  buffer_load_dwordx4 v6, s[12:15], s49 offen offset:2048 nt lds
  buffer_load_dwordx4 v6, s[12:15], s49 offen offset:3072 nt lds
  s_mov_b32 m0, 49152
  s_mov_b32 s49, 229376
  buffer_load_dwordx4 v2, s[8:11], s49 offen offset:0 nt lds
  buffer_load_dwordx4 v3, s[8:11], s49 offen offset:1024 nt lds
  buffer_load_dwordx4 v4, s[8:11], s49 offen offset:2048 nt lds
  buffer_load_dwordx4 v5, s[8:11], s49 offen offset:3072 nt lds
  s_mov_b32 m0, 53248
  s_mov_b32 s49, 233472
  buffer_load_dwordx4 v2, s[8:11], s49 offen offset:0 nt lds
  buffer_load_dwordx4 v3, s[8:11], s49 offen offset:1024 nt lds
  buffer_load_dwordx4 v4, s[8:11], s49 offen offset:2048 nt lds
  buffer_load_dwordx4 v5, s[8:11], s49 offen offset:3072 nt lds
  s_mov_b32 m0, 57344
  s_mov_b32 s49, 237568
  buffer_load_dwordx4 v2, s[8:11], s49 offen offset:0 nt lds
  buffer_load_dwordx4 v3, s[8:11], s49 offen offset:1024 nt lds
  buffer_load_dwordx4 v4, s[8:11], s49 offen offset:2048 nt lds
  buffer_load_dwordx4 v5, s[8:11], s49 offen offset:3072 nt lds
  s_mov_b32 m0, 61440
  s_mov_b32 s49, 241664
  buffer_load_dwordx4 v2, s[8:11], s49 offen offset:0 nt lds
  buffer_load_dwordx4 v3, s[8:11], s49 offen offset:1024 nt lds
  buffer_load_dwordx4 v4, s[8:11], s49 offen offset:2048 nt lds
  buffer_load_dwordx4 v5, s[8:11], s49 offen offset:3072 nt lds
  s_waitcnt vmcnt(32)
  s_barrier
  s_mov_b32 m0, 65536
  s_mov_b32 s49, 229376
  buffer_load_dwordx4 v6, s[12:15], s49 offen offset:0 nt lds
  buffer_load_dwordx4 v6, s[12:15], s49 offen offset:1024 nt lds
  buffer_load_dwordx4 v6, s[12:15], s49 offen offset:2048 nt lds
  buffer_load_dwordx4 v6, s[12:15], s49 offen offset:3072 nt lds
  s_mov_b32 m0, 69632
  s_mov_b32 s49, 233472
  buffer_load_dwordx4 v6, s[12:15], s49 offen offset:0 nt lds
  buffer_load_dwordx4 v6, s[12:15], s49 offen offset:1024 nt lds
  buffer_load_dwordx4 v6, s[12:15], s49 offen offset:2048 nt lds
  buffer_load_dwordx4 v6, s[12:15], s49 offen offset:3072 nt lds
  s_mov_b32 m0, 73728
  s_mov_b32 s49, 237568
  buffer_load_dwordx4 v6, s[12:15], s49 offen offset:0 nt lds
  buffer_load_dwordx4 v6, s[12:15], s49 offen offset:1024 nt lds
  buffer_load_dwordx4 v6, s[12:15], s49 offen offset:2048 nt lds
  buffer_load_dwordx4 v6, s[12:15], s49 offen offset:3072 nt lds
  s_mov_b32 m0, 77824
  s_mov_b32 s49, 241664
  buffer_load_dwordx4 v6, s[12:15], s49 offen offset:0 nt lds
  buffer_load_dwordx4 v6, s[12:15], s49 offen offset:1024 nt lds
  buffer_load_dwordx4 v6, s[12:15], s49 offen offset:2048 nt lds
  buffer_load_dwordx4 v6, s[12:15], s49 offen offset:3072 nt lds
  s_mov_b32 m0, 81920
  s_mov_b32 s49, 245760
  buffer_load_dwordx4 v2, s[8:11], s49 offen offset:0 nt lds
  buffer_load_dwordx4 v3, s[8:11], s49 offen offset:1024 nt lds
  buffer_load_dwordx4 v4, s[8:11], s49 offen offset:2048 nt lds
  buffer_load_dwordx4 v5, s[8:11], s49 offen offset:3072 nt lds
  s_mov_b32 m0, 86016
  s_mov_b32 s49, 249856
  buffer_load_dwordx4 v2, s[8:11], s49 offen offset:0 nt lds
  buffer_load_dwordx4 v3, s[8:11], s49 offen offset:1024 nt lds
  buffer_load_dwordx4 v4, s[8:11], s49 offen offset:2048 nt lds
  buffer_load_dwordx4 v5, s[8:11], s49 offen offset:3072 nt lds
  s_mov_b32 m0, 90112
  s_mov_b32 s49, 253952
  buffer_load_dwordx4 v2, s[8:11], s49 offen offset:0 nt lds
  buffer_load_dwordx4 v3, s[8:11], s49 offen offset:1024 nt lds
  buffer_load_dwordx4 v4, s[8:11], s49 offen offset:2048 nt lds
  buffer_load_dwordx4 v5, s[8:11], s49 offen offset:3072 nt lds
  s_mov_b32 m0, 94208
  s_mov_b32 s49, 258048
  buffer_load_dwordx4 v2, s[8:11], s49 offen offset:0 nt lds
  buffer_load_dwordx4 v3, s[8:11], s49 offen offset:1024 nt lds
  buffer_load_dwordx4 v4, s[8:11], s49 offen offset:2048 nt lds
  buffer_load_dwordx4 v5, s[8:11], s49 offen offset:3072 nt lds
  s_waitcnt vmcnt(32)
  s_barrier
  s_mov_b32 m0, 98304
  s_mov_b32 s49, 245760
  buffer_load_dwordx4 v6, s[12:15], s49 offen offset:0 nt lds
  buffer_load_dwordx4 v6, s[12:15], s49 offen offset:1024 nt lds
  buffer_load_dwordx4 v6, s[12:15], s49 offen offset:2048 nt lds
  buffer_load_dwordx4 v6, s[12:15], s49 offen offset:3072 nt lds
  s_mov_b32 m0, 102400
  s_mov_b32 s49, 249856
  buffer_load_dwordx4 v6, s[12:15], s49 offen offset:0 nt lds
  buffer_load_dwordx4 v6, s[12:15], s49 offen offset:1024 nt lds
  buffer_load_dwordx4 v6, s[12:15], s49 offen offset:2048 nt lds
  buffer_load_dwordx4 v6, s[12:15], s49 offen offset:3072 nt lds
  s_mov_b32 m0, 106496
  s_mov_b32 s49, 253952
  buffer_load_dwordx4 v6, s[12:15], s49 offen offset:0 nt lds
  buffer_load_dwordx4 v6, s[12:15], s49 offen offset:1024 nt lds
  buffer_load_dwordx4 v6, s[12:15], s49 offen offset:2048 nt lds
  buffer_load_dwordx4 v6, s[12:15], s49 offen offset:3072 nt lds
  s_mov_b32 m0, 110592
  s_mov_b32 s49, 258048
  buffer_load_dwordx4 v6, s[12:15], s49 offen offset:0 nt lds
  buffer_load_dwordx4 v6, s[12:15], s49 offen offset:1024 nt lds
  buffer_load_dwordx4 v6, s[12:15], s49 offen offset:2048 nt lds
  buffer_load_dwordx4 v6, s[12:15], s49 offen offset:3072 nt lds
  s_waitcnt vmcnt(16)
  s_barrier
  s_waitcnt vmcnt(0)
  s_barrier
K1_END:
  s_endpgm
.globl mha_oproj_kernel
.p2align 8
.type mha_oproj_kernel,@function
mha_oproj_kernel:
  s_cmp_ge_u32 s2, 224
  s_cbranch_scc1 K2_END
  s_load_dwordx2 s[12:13], s[0:1], 40
  s_load_dwordx2 s[14:15], s[0:1], 56
  s_and_b32 s16, s2, 7
  s_lshr_b32 s17, s2, 3
  s_mul_i32 s18, s17, 37
  s_lshr_b32 s18, s18, 8
  s_mul_i32 s19, s18, 7
  s_sub_u32 s19, s17, s19
  s_lshr_b32 s20, s16, 1
  s_mul_i32 s20, s20, 7
  s_add_u32 s20, s20, s19
  s_and_b32 s21, s16, 1
  s_lshl_b32 s21, s21, 2
  s_add_u32 s21, s21, s18
  v_lshrrev_b32 v193, 6, v0
  v_and_b32 v194, 63, v0
  s_nop 0
  v_readfirstlane_b32 s22, v193
  v_lshlrev_b32 v195, 4, v194
  s_waitcnt lgkmcnt(0)
  s_mov_b32 s4, s14
  s_and_b32 s5, s15, 0xffff
  s_mov_b32 s6, 20971520
  s_mov_b32 s7, 0x20000
  s_mov_b32 s8, s12
  s_and_b32 s9, s13, 0xffff
  s_mov_b32 s10, 1835008
  s_mov_b32 s11, 0x20000
  s_lshl_b32 s23, s22, 15
  s_lshl_b32 s24, s20, 19
  v_add_u32 v204, s24, v195
  v_add_u32 v205, 0x40000, v204
  s_lshl_b32 s26, s21, 19
  s_add_u32 s26, s26, 16777216
  v_add_u32 v206, s26, v195
  v_add_u32 v207, 0x40000, v206
  buffer_load_dwordx4 v[64:67], v204, s[4:7], s23 offen
  buffer_load_dwordx4 v[68:71], v205, s[4:7], s23 offen
  buffer_load_dwordx4 v[72:75], v206, s[4:7], s23 offen
  buffer_load_dwordx4 v[76:79], v207, s[4:7], s23 offen
  s_add_u32 s23, s23, 1024
  buffer_load_dwordx4 v[80:83], v204, s[4:7], s23 offen
  buffer_load_dwordx4 v[84:87], v205, s[4:7], s23 offen
  buffer_load_dwordx4 v[88:91], v206, s[4:7], s23 offen
  buffer_load_dwordx4 v[92:95], v207, s[4:7], s23 offen
  s_add_u32 s23, s23, 1024
  buffer_load_dwordx4 v[96:99], v204, s[4:7], s23 offen
  buffer_load_dwordx4 v[100:103], v205, s[4:7], s23 offen
  buffer_load_dwordx4 v[104:107], v206, s[4:7], s23 offen
  buffer_load_dwordx4 v[108:111], v207, s[4:7], s23 offen
  s_add_u32 s23, s23, 1024
  buffer_load_dwordx4 v[112:115], v204, s[4:7], s23 offen
  buffer_load_dwordx4 v[116:119], v205, s[4:7], s23 offen
  buffer_load_dwordx4 v[120:123], v206, s[4:7], s23 offen
  buffer_load_dwordx4 v[124:127], v207, s[4:7], s23 offen
  s_add_u32 s23, s23, 1024
  buffer_load_dwordx4 v[128:131], v204, s[4:7], s23 offen
  buffer_load_dwordx4 v[132:135], v205, s[4:7], s23 offen
  buffer_load_dwordx4 v[136:139], v206, s[4:7], s23 offen
  buffer_load_dwordx4 v[140:143], v207, s[4:7], s23 offen
  s_add_u32 s23, s23, 1024
  buffer_load_dwordx4 v[144:147], v204, s[4:7], s23 offen
  buffer_load_dwordx4 v[148:151], v205, s[4:7], s23 offen
  buffer_load_dwordx4 v[152:155], v206, s[4:7], s23 offen
  buffer_load_dwordx4 v[156:159], v207, s[4:7], s23 offen
  s_add_u32 s23, s23, 1024
  buffer_load_dwordx4 v[160:163], v204, s[4:7], s23 offen
  buffer_load_dwordx4 v[164:167], v205, s[4:7], s23 offen
  buffer_load_dwordx4 v[168:171], v206, s[4:7], s23 offen
  buffer_load_dwordx4 v[172:175], v207, s[4:7], s23 offen
  s_add_u32 s23, s23, 1024
  buffer_load_dwordx4 v[176:179], v204, s[4:7], s23 offen
  buffer_load_dwordx4 v[180:183], v205, s[4:7], s23 offen
  buffer_load_dwordx4 v[184:187], v206, s[4:7], s23 offen
  buffer_load_dwordx4 v[188:191], v207, s[4:7], s23 offen
  s_waitcnt vmcnt(28)
  v_mfma_f32_32x32x16_bf16 v[0:15], v[72:75], v[64:67], 0
  v_mfma_f32_32x32x16_bf16 v[16:31], v[72:75], v[68:71], 0
  v_mfma_f32_32x32x16_bf16 v[32:47], v[76:79], v[64:67], 0
  v_mfma_f32_32x32x16_bf16 v[48:63], v[76:79], v[68:71], 0
  s_add_u32 s23, s23, 1024
  buffer_load_dwordx4 v[64:67], v204, s[4:7], s23 offen
  buffer_load_dwordx4 v[68:71], v205, s[4:7], s23 offen
  buffer_load_dwordx4 v[72:75], v206, s[4:7], s23 offen
  buffer_load_dwordx4 v[76:79], v207, s[4:7], s23 offen
  s_waitcnt vmcnt(28)
  v_mfma_f32_32x32x16_bf16 v[0:15], v[88:91], v[80:83], v[0:15]
  v_mfma_f32_32x32x16_bf16 v[16:31], v[88:91], v[84:87], v[16:31]
  v_mfma_f32_32x32x16_bf16 v[32:47], v[92:95], v[80:83], v[32:47]
  v_mfma_f32_32x32x16_bf16 v[48:63], v[92:95], v[84:87], v[48:63]
  s_add_u32 s23, s23, 1024
  buffer_load_dwordx4 v[80:83], v204, s[4:7], s23 offen
  buffer_load_dwordx4 v[84:87], v205, s[4:7], s23 offen
  buffer_load_dwordx4 v[88:91], v206, s[4:7], s23 offen
  buffer_load_dwordx4 v[92:95], v207, s[4:7], s23 offen
  s_waitcnt vmcnt(28)
  v_mfma_f32_32x32x16_bf16 v[0:15], v[104:107], v[96:99], v[0:15]
  v_mfma_f32_32x32x16_bf16 v[16:31], v[104:107], v[100:103], v[16:31]
  v_mfma_f32_32x32x16_bf16 v[32:47], v[108:111], v[96:99], v[32:47]
  v_mfma_f32_32x32x16_bf16 v[48:63], v[108:111], v[100:103], v[48:63]
  s_add_u32 s23, s23, 1024
  buffer_load_dwordx4 v[96:99], v204, s[4:7], s23 offen
  buffer_load_dwordx4 v[100:103], v205, s[4:7], s23 offen
  buffer_load_dwordx4 v[104:107], v206, s[4:7], s23 offen
  buffer_load_dwordx4 v[108:111], v207, s[4:7], s23 offen
  s_waitcnt vmcnt(28)
  v_mfma_f32_32x32x16_bf16 v[0:15], v[120:123], v[112:115], v[0:15]
  v_mfma_f32_32x32x16_bf16 v[16:31], v[120:123], v[116:119], v[16:31]
  v_mfma_f32_32x32x16_bf16 v[32:47], v[124:127], v[112:115], v[32:47]
  v_mfma_f32_32x32x16_bf16 v[48:63], v[124:127], v[116:119], v[48:63]
  s_add_u32 s23, s23, 1024
  buffer_load_dwordx4 v[112:115], v204, s[4:7], s23 offen
  buffer_load_dwordx4 v[116:119], v205, s[4:7], s23 offen
  buffer_load_dwordx4 v[120:123], v206, s[4:7], s23 offen
  buffer_load_dwordx4 v[124:127], v207, s[4:7], s23 offen
  s_waitcnt vmcnt(28)
  v_mfma_f32_32x32x16_bf16 v[0:15], v[136:139], v[128:131], v[0:15]
  v_mfma_f32_32x32x16_bf16 v[16:31], v[136:139], v[132:135], v[16:31]
  v_mfma_f32_32x32x16_bf16 v[32:47], v[140:143], v[128:131], v[32:47]
  v_mfma_f32_32x32x16_bf16 v[48:63], v[140:143], v[132:135], v[48:63]
  s_add_u32 s23, s23, 1024
  buffer_load_dwordx4 v[128:131], v204, s[4:7], s23 offen
  buffer_load_dwordx4 v[132:135], v205, s[4:7], s23 offen
  buffer_load_dwordx4 v[136:139], v206, s[4:7], s23 offen
  buffer_load_dwordx4 v[140:143], v207, s[4:7], s23 offen
  s_waitcnt vmcnt(28)
  v_mfma_f32_32x32x16_bf16 v[0:15], v[152:155], v[144:147], v[0:15]
  v_mfma_f32_32x32x16_bf16 v[16:31], v[152:155], v[148:151], v[16:31]
  v_mfma_f32_32x32x16_bf16 v[32:47], v[156:159], v[144:147], v[32:47]
  v_mfma_f32_32x32x16_bf16 v[48:63], v[156:159], v[148:151], v[48:63]
  s_add_u32 s23, s23, 1024
  buffer_load_dwordx4 v[144:147], v204, s[4:7], s23 offen
  buffer_load_dwordx4 v[148:151], v205, s[4:7], s23 offen
  buffer_load_dwordx4 v[152:155], v206, s[4:7], s23 offen
  buffer_load_dwordx4 v[156:159], v207, s[4:7], s23 offen
  s_waitcnt vmcnt(28)
  v_mfma_f32_32x32x16_bf16 v[0:15], v[168:171], v[160:163], v[0:15]
  v_mfma_f32_32x32x16_bf16 v[16:31], v[168:171], v[164:167], v[16:31]
  v_mfma_f32_32x32x16_bf16 v[32:47], v[172:175], v[160:163], v[32:47]
  v_mfma_f32_32x32x16_bf16 v[48:63], v[172:175], v[164:167], v[48:63]
  s_add_u32 s23, s23, 1024
  buffer_load_dwordx4 v[160:163], v204, s[4:7], s23 offen
  buffer_load_dwordx4 v[164:167], v205, s[4:7], s23 offen
  buffer_load_dwordx4 v[168:171], v206, s[4:7], s23 offen
  buffer_load_dwordx4 v[172:175], v207, s[4:7], s23 offen
  s_waitcnt vmcnt(28)
  v_mfma_f32_32x32x16_bf16 v[0:15], v[184:187], v[176:179], v[0:15]
  v_mfma_f32_32x32x16_bf16 v[16:31], v[184:187], v[180:183], v[16:31]
  v_mfma_f32_32x32x16_bf16 v[32:47], v[188:191], v[176:179], v[32:47]
  v_mfma_f32_32x32x16_bf16 v[48:63], v[188:191], v[180:183], v[48:63]
  s_add_u32 s23, s23, 1024
  buffer_load_dwordx4 v[176:179], v204, s[4:7], s23 offen
  buffer_load_dwordx4 v[180:183], v205, s[4:7], s23 offen
  buffer_load_dwordx4 v[184:187], v206, s[4:7], s23 offen
  buffer_load_dwordx4 v[188:191], v207, s[4:7], s23 offen
  s_waitcnt vmcnt(28)
  v_mfma_f32_32x32x16_bf16 v[0:15], v[72:75], v[64:67], v[0:15]
  v_mfma_f32_32x32x16_bf16 v[16:31], v[72:75], v[68:71], v[16:31]
  v_mfma_f32_32x32x16_bf16 v[32:47], v[76:79], v[64:67], v[32:47]
  v_mfma_f32_32x32x16_bf16 v[48:63], v[76:79], v[68:71], v[48:63]
  s_add_u32 s23, s23, 1024
  buffer_load_dwordx4 v[64:67], v204, s[4:7], s23 offen
  buffer_load_dwordx4 v[68:71], v205, s[4:7], s23 offen
  buffer_load_dwordx4 v[72:75], v206, s[4:7], s23 offen
  buffer_load_dwordx4 v[76:79], v207, s[4:7], s23 offen
  s_waitcnt vmcnt(28)
  v_mfma_f32_32x32x16_bf16 v[0:15], v[88:91], v[80:83], v[0:15]
  v_mfma_f32_32x32x16_bf16 v[16:31], v[88:91], v[84:87], v[16:31]
  v_mfma_f32_32x32x16_bf16 v[32:47], v[92:95], v[80:83], v[32:47]
  v_mfma_f32_32x32x16_bf16 v[48:63], v[92:95], v[84:87], v[48:63]
  s_add_u32 s23, s23, 1024
  buffer_load_dwordx4 v[80:83], v204, s[4:7], s23 offen
  buffer_load_dwordx4 v[84:87], v205, s[4:7], s23 offen
  buffer_load_dwordx4 v[88:91], v206, s[4:7], s23 offen
  buffer_load_dwordx4 v[92:95], v207, s[4:7], s23 offen
  s_waitcnt vmcnt(28)
  v_mfma_f32_32x32x16_bf16 v[0:15], v[104:107], v[96:99], v[0:15]
  v_mfma_f32_32x32x16_bf16 v[16:31], v[104:107], v[100:103], v[16:31]
  v_mfma_f32_32x32x16_bf16 v[32:47], v[108:111], v[96:99], v[32:47]
  v_mfma_f32_32x32x16_bf16 v[48:63], v[108:111], v[100:103], v[48:63]
  s_add_u32 s23, s23, 1024
  buffer_load_dwordx4 v[96:99], v204, s[4:7], s23 offen
  buffer_load_dwordx4 v[100:103], v205, s[4:7], s23 offen
  buffer_load_dwordx4 v[104:107], v206, s[4:7], s23 offen
  buffer_load_dwordx4 v[108:111], v207, s[4:7], s23 offen
  s_waitcnt vmcnt(28)
  v_mfma_f32_32x32x16_bf16 v[0:15], v[120:123], v[112:115], v[0:15]
  v_mfma_f32_32x32x16_bf16 v[16:31], v[120:123], v[116:119], v[16:31]
  v_mfma_f32_32x32x16_bf16 v[32:47], v[124:127], v[112:115], v[32:47]
  v_mfma_f32_32x32x16_bf16 v[48:63], v[124:127], v[116:119], v[48:63]
  s_add_u32 s23, s23, 1024
  buffer_load_dwordx4 v[112:115], v204, s[4:7], s23 offen
  buffer_load_dwordx4 v[116:119], v205, s[4:7], s23 offen
  buffer_load_dwordx4 v[120:123], v206, s[4:7], s23 offen
  buffer_load_dwordx4 v[124:127], v207, s[4:7], s23 offen
  s_waitcnt vmcnt(28)
  v_mfma_f32_32x32x16_bf16 v[0:15], v[136:139], v[128:131], v[0:15]
  v_mfma_f32_32x32x16_bf16 v[16:31], v[136:139], v[132:135], v[16:31]
  v_mfma_f32_32x32x16_bf16 v[32:47], v[140:143], v[128:131], v[32:47]
  v_mfma_f32_32x32x16_bf16 v[48:63], v[140:143], v[132:135], v[48:63]
  s_add_u32 s23, s23, 1024
  buffer_load_dwordx4 v[128:131], v204, s[4:7], s23 offen
  buffer_load_dwordx4 v[132:135], v205, s[4:7], s23 offen
  buffer_load_dwordx4 v[136:139], v206, s[4:7], s23 offen
  buffer_load_dwordx4 v[140:143], v207, s[4:7], s23 offen
  s_waitcnt vmcnt(28)
  v_mfma_f32_32x32x16_bf16 v[0:15], v[152:155], v[144:147], v[0:15]
  v_mfma_f32_32x32x16_bf16 v[16:31], v[152:155], v[148:151], v[16:31]
  v_mfma_f32_32x32x16_bf16 v[32:47], v[156:159], v[144:147], v[32:47]
  v_mfma_f32_32x32x16_bf16 v[48:63], v[156:159], v[148:151], v[48:63]
  s_add_u32 s23, s23, 1024
  buffer_load_dwordx4 v[144:147], v204, s[4:7], s23 offen
  buffer_load_dwordx4 v[148:151], v205, s[4:7], s23 offen
  buffer_load_dwordx4 v[152:155], v206, s[4:7], s23 offen
  buffer_load_dwordx4 v[156:159], v207, s[4:7], s23 offen
  s_waitcnt vmcnt(28)
  v_mfma_f32_32x32x16_bf16 v[0:15], v[168:171], v[160:163], v[0:15]
  v_mfma_f32_32x32x16_bf16 v[16:31], v[168:171], v[164:167], v[16:31]
  v_mfma_f32_32x32x16_bf16 v[32:47], v[172:175], v[160:163], v[32:47]
  v_mfma_f32_32x32x16_bf16 v[48:63], v[172:175], v[164:167], v[48:63]
  s_add_u32 s23, s23, 1024
  buffer_load_dwordx4 v[160:163], v204, s[4:7], s23 offen
  buffer_load_dwordx4 v[164:167], v205, s[4:7], s23 offen
  buffer_load_dwordx4 v[168:171], v206, s[4:7], s23 offen
  buffer_load_dwordx4 v[172:175], v207, s[4:7], s23 offen
  s_waitcnt vmcnt(28)
  v_mfma_f32_32x32x16_bf16 v[0:15], v[184:187], v[176:179], v[0:15]
  v_mfma_f32_32x32x16_bf16 v[16:31], v[184:187], v[180:183], v[16:31]
  v_mfma_f32_32x32x16_bf16 v[32:47], v[188:191], v[176:179], v[32:47]
  v_mfma_f32_32x32x16_bf16 v[48:63], v[188:191], v[180:183], v[48:63]
  s_add_u32 s23, s23, 1024
  buffer_load_dwordx4 v[176:179], v204, s[4:7], s23 offen
  buffer_load_dwordx4 v[180:183], v205, s[4:7], s23 offen
  buffer_load_dwordx4 v[184:187], v206, s[4:7], s23 offen
  buffer_load_dwordx4 v[188:191], v207, s[4:7], s23 offen
  s_waitcnt vmcnt(28)
  v_mfma_f32_32x32x16_bf16 v[0:15], v[72:75], v[64:67], v[0:15]
  v_mfma_f32_32x32x16_bf16 v[16:31], v[72:75], v[68:71], v[16:31]
  v_mfma_f32_32x32x16_bf16 v[32:47], v[76:79], v[64:67], v[32:47]
  v_mfma_f32_32x32x16_bf16 v[48:63], v[76:79], v[68:71], v[48:63]
  s_add_u32 s23, s23, 1024
  buffer_load_dwordx4 v[64:67], v204, s[4:7], s23 offen
  buffer_load_dwordx4 v[68:71], v205, s[4:7], s23 offen
  buffer_load_dwordx4 v[72:75], v206, s[4:7], s23 offen
  buffer_load_dwordx4 v[76:79], v207, s[4:7], s23 offen
  s_waitcnt vmcnt(28)
  v_mfma_f32_32x32x16_bf16 v[0:15], v[88:91], v[80:83], v[0:15]
  v_mfma_f32_32x32x16_bf16 v[16:31], v[88:91], v[84:87], v[16:31]
  v_mfma_f32_32x32x16_bf16 v[32:47], v[92:95], v[80:83], v[32:47]
  v_mfma_f32_32x32x16_bf16 v[48:63], v[92:95], v[84:87], v[48:63]
  s_add_u32 s23, s23, 1024
  buffer_load_dwordx4 v[80:83], v204, s[4:7], s23 offen
  buffer_load_dwordx4 v[84:87], v205, s[4:7], s23 offen
  buffer_load_dwordx4 v[88:91], v206, s[4:7], s23 offen
  buffer_load_dwordx4 v[92:95], v207, s[4:7], s23 offen
  s_waitcnt vmcnt(28)
  v_mfma_f32_32x32x16_bf16 v[0:15], v[104:107], v[96:99], v[0:15]
  v_mfma_f32_32x32x16_bf16 v[16:31], v[104:107], v[100:103], v[16:31]
  v_mfma_f32_32x32x16_bf16 v[32:47], v[108:111], v[96:99], v[32:47]
  v_mfma_f32_32x32x16_bf16 v[48:63], v[108:111], v[100:103], v[48:63]
  s_add_u32 s23, s23, 1024
  buffer_load_dwordx4 v[96:99], v204, s[4:7], s23 offen
  buffer_load_dwordx4 v[100:103], v205, s[4:7], s23 offen
  buffer_load_dwordx4 v[104:107], v206, s[4:7], s23 offen
  buffer_load_dwordx4 v[108:111], v207, s[4:7], s23 offen
  s_waitcnt vmcnt(28)
  v_mfma_f32_32x32x16_bf16 v[0:15], v[120:123], v[112:115], v[0:15]
  v_mfma_f32_32x32x16_bf16 v[16:31], v[120:123], v[116:119], v[16:31]
  v_mfma_f32_32x32x16_bf16 v[32:47], v[124:127], v[112:115], v[32:47]
  v_mfma_f32_32x32x16_bf16 v[48:63], v[124:127], v[116:119], v[48:63]
  s_add_u32 s23, s23, 1024
  buffer_load_dwordx4 v[112:115], v204, s[4:7], s23 offen
  buffer_load_dwordx4 v[116:119], v205, s[4:7], s23 offen
  buffer_load_dwordx4 v[120:123], v206, s[4:7], s23 offen
  buffer_load_dwordx4 v[124:127], v207, s[4:7], s23 offen
  s_waitcnt vmcnt(28)
  v_mfma_f32_32x32x16_bf16 v[0:15], v[136:139], v[128:131], v[0:15]
  v_mfma_f32_32x32x16_bf16 v[16:31], v[136:139], v[132:135], v[16:31]
  v_mfma_f32_32x32x16_bf16 v[32:47], v[140:143], v[128:131], v[32:47]
  v_mfma_f32_32x32x16_bf16 v[48:63], v[140:143], v[132:135], v[48:63]
  s_add_u32 s23, s23, 1024
  buffer_load_dwordx4 v[128:131], v204, s[4:7], s23 offen
  buffer_load_dwordx4 v[132:135], v205, s[4:7], s23 offen
  buffer_load_dwordx4 v[136:139], v206, s[4:7], s23 offen
  buffer_load_dwordx4 v[140:143], v207, s[4:7], s23 offen
  s_waitcnt vmcnt(28)
  v_mfma_f32_32x32x16_bf16 v[0:15], v[152:155], v[144:147], v[0:15]
  v_mfma_f32_32x32x16_bf16 v[16:31], v[152:155], v[148:151], v[16:31]
  v_mfma_f32_32x32x16_bf16 v[32:47], v[156:159], v[144:147], v[32:47]
  v_mfma_f32_32x32x16_bf16 v[48:63], v[156:159], v[148:151], v[48:63]
  s_add_u32 s23, s23, 1024
  buffer_load_dwordx4 v[144:147], v204, s[4:7], s23 offen
  buffer_load_dwordx4 v[148:151], v205, s[4:7], s23 offen
  buffer_load_dwordx4 v[152:155], v206, s[4:7], s23 offen
  buffer_load_dwordx4 v[156:159], v207, s[4:7], s23 offen
  s_waitcnt vmcnt(28)
  v_mfma_f32_32x32x16_bf16 v[0:15], v[168:171], v[160:163], v[0:15]
  v_mfma_f32_32x32x16_bf16 v[16:31], v[168:171], v[164:167], v[16:31]
  v_mfma_f32_32x32x16_bf16 v[32:47], v[172:175], v[160:163], v[32:47]
  v_mfma_f32_32x32x16_bf16 v[48:63], v[172:175], v[164:167], v[48:63]
  s_add_u32 s23, s23, 1024
  buffer_load_dwordx4 v[160:163], v204, s[4:7], s23 offen
  buffer_load_dwordx4 v[164:167], v205, s[4:7], s23 offen
  buffer_load_dwordx4 v[168:171], v206, s[4:7], s23 offen
  buffer_load_dwordx4 v[172:175], v207, s[4:7], s23 offen
  s_waitcnt vmcnt(28)
  v_mfma_f32_32x32x16_bf16 v[0:15], v[184:187], v[176:179], v[0:15]
  v_mfma_f32_32x32x16_bf16 v[16:31], v[184:187], v[180:183], v[16:31]
  v_mfma_f32_32x32x16_bf16 v[32:47], v[188:191], v[176:179], v[32:47]
  v_mfma_f32_32x32x16_bf16 v[48:63], v[188:191], v[180:183], v[48:63]
  s_add_u32 s23, s23, 1024
  buffer_load_dwordx4 v[176:179], v204, s[4:7], s23 offen
  buffer_load_dwordx4 v[180:183], v205, s[4:7], s23 offen
  buffer_load_dwordx4 v[184:187], v206, s[4:7], s23 offen
  buffer_load_dwordx4 v[188:191], v207, s[4:7], s23 offen
  s_waitcnt vmcnt(28)
  v_mfma_f32_32x32x16_bf16 v[0:15], v[72:75], v[64:67], v[0:15]
  v_mfma_f32_32x32x16_bf16 v[16:31], v[72:75], v[68:71], v[16:31]
  v_mfma_f32_32x32x16_bf16 v[32:47], v[76:79], v[64:67], v[32:47]
  v_mfma_f32_32x32x16_bf16 v[48:63], v[76:79], v[68:71], v[48:63]
  s_waitcnt vmcnt(24)
  v_mfma_f32_32x32x16_bf16 v[0:15], v[88:91], v[80:83], v[0:15]
  v_mfma_f32_32x32x16_bf16 v[16:31], v[88:91], v[84:87], v[16:31]
  v_mfma_f32_32x32x16_bf16 v[32:47], v[92:95], v[80:83], v[32:47]
  v_mfma_f32_32x32x16_bf16 v[48:63], v[92:95], v[84:87], v[48:63]
  s_waitcnt vmcnt(20)
  v_mfma_f32_32x32x16_bf16 v[0:15], v[104:107], v[96:99], v[0:15]
  v_mfma_f32_32x32x16_bf16 v[16:31], v[104:107], v[100:103], v[16:31]
  v_mfma_f32_32x32x16_bf16 v[32:47], v[108:111], v[96:99], v[32:47]
  v_mfma_f32_32x32x16_bf16 v[48:63], v[108:111], v[100:103], v[48:63]
  s_waitcnt vmcnt(16)
  v_mfma_f32_32x32x16_bf16 v[0:15], v[120:123], v[112:115], v[0:15]
  v_mfma_f32_32x32x16_bf16 v[16:31], v[120:123], v[116:119], v[16:31]
  v_mfma_f32_32x32x16_bf16 v[32:47], v[124:127], v[112:115], v[32:47]
  v_mfma_f32_32x32x16_bf16 v[48:63], v[124:127], v[116:119], v[48:63]
  s_waitcnt vmcnt(12)
  v_mfma_f32_32x32x16_bf16 v[0:15], v[136:139], v[128:131], v[0:15]
  v_mfma_f32_32x32x16_bf16 v[16:31], v[136:139], v[132:135], v[16:31]
  v_mfma_f32_32x32x16_bf16 v[32:47], v[140:143], v[128:131], v[32:47]
  v_mfma_f32_32x32x16_bf16 v[48:63], v[140:143], v[132:135], v[48:63]
  s_waitcnt vmcnt(8)
  v_mfma_f32_32x32x16_bf16 v[0:15], v[152:155], v[144:147], v[0:15]
  v_mfma_f32_32x32x16_bf16 v[16:31], v[152:155], v[148:151], v[16:31]
  v_mfma_f32_32x32x16_bf16 v[32:47], v[156:159], v[144:147], v[32:47]
  v_mfma_f32_32x32x16_bf16 v[48:63], v[156:159], v[148:151], v[48:63]
  s_waitcnt vmcnt(4)
  v_mfma_f32_32x32x16_bf16 v[0:15], v[168:171], v[160:163], v[0:15]
  v_mfma_f32_32x32x16_bf16 v[16:31], v[168:171], v[164:167], v[16:31]
  v_mfma_f32_32x32x16_bf16 v[32:47], v[172:175], v[160:163], v[32:47]
  v_mfma_f32_32x32x16_bf16 v[48:63], v[172:175], v[164:167], v[48:63]
  s_waitcnt vmcnt(0)
  v_mfma_f32_32x32x16_bf16 v[0:15], v[184:187], v[176:179], v[0:15]
  v_mfma_f32_32x32x16_bf16 v[16:31], v[184:187], v[180:183], v[16:31]
  v_mfma_f32_32x32x16_bf16 v[32:47], v[188:191], v[176:179], v[32:47]
  v_mfma_f32_32x32x16_bf16 v[48:63], v[188:191], v[180:183], v[48:63]
  s_nop 15
  s_lshl_b32 s23, s22, 14
  v_add_u32 v196, s23, v195
  ds_write_b128 v196, v[0:3] offset:0
  ds_write_b128 v196, v[4:7] offset:1024
  ds_write_b128 v196, v[8:11] offset:2048
  ds_write_b128 v196, v[12:15] offset:3072
  ds_write_b128 v196, v[16:19] offset:4096
  ds_write_b128 v196, v[20:23] offset:5120
  ds_write_b128 v196, v[24:27] offset:6144
  ds_write_b128 v196, v[28:31] offset:7168
  ds_write_b128 v196, v[32:35] offset:8192
  ds_write_b128 v196, v[36:39] offset:9216
  ds_write_b128 v196, v[40:43] offset:10240
  ds_write_b128 v196, v[44:47] offset:11264
  ds_write_b128 v196, v[48:51] offset:12288
  ds_write_b128 v196, v[52:55] offset:13312
  ds_write_b128 v196, v[56:59] offset:14336
  ds_write_b128 v196, v[60:63] offset:15360
  s_waitcnt lgkmcnt(0)
  s_barrier
  s_lshl_b32 s23, s22, 11
  v_add_u32 v196, s23, v195
  v_add_u32 v197, 0x10000, v196
  ds_read_b128 v[64:67], v196 offset:0
  ds_read_b128 v[68:71], v196 offset:1024
  ds_read_b128 v[72:75], v196 offset:16384
  ds_read_b128 v[76:79], v196 offset:17408
  ds_read_b128 v[80:83], v196 offset:32768
  ds_read_b128 v[84:87], v196 offset:33792
  ds_read_b128 v[88:91], v196 offset:49152
  ds_read_b128 v[92:95], v196 offset:50176
  ds_read_b128 v[96:99], v197 offset:0
  ds_read_b128 v[100:103], v197 offset:1024
  ds_read_b128 v[104:107], v197 offset:16384
  ds_read_b128 v[108:111], v197 offset:17408
  ds_read_b128 v[112:115], v197 offset:32768
  ds_read_b128 v[116:119], v197 offset:33792
  ds_read_b128 v[120:123], v197 offset:49152
  ds_read_b128 v[124:127], v197 offset:50176
  s_lshr_b32 s24, s22, 2
  s_bfe_u32 s25, s22, 0x10001
  s_and_b32 s26, s22, 1
  s_lshl_b32 s27, s20, 6
  s_lshl_b32 s25, s25, 5
  s_add_u32 s27, s27, s25
  s_lshl_b32 s27, s27, 10
  s_lshl_b32 s28, s21, 7
  s_lshl_b32 s24, s24, 6
  s_lshl_b32 s26, s26, 5
  s_add_u32 s27, s27, s28
  s_add_u32 s27, s27, s24
  s_add_u32 s27, s27, s26
  v_and_b32 v198, 31, v194
  v_lshrrev_b32 v199, 5, v194
  v_lshlrev_b32 v199, 4, v199
  v_lshl_add_u32 v198, v198, 10, v199
  s_waitcnt lgkmcnt(12)
  v_add_f32 v64, v64, v72
  v_add_f32 v65, v65, v73
  v_add_f32 v66, v66, v74
  v_add_f32 v67, v67, v75
  v_add_f32 v68, v68, v76
  v_add_f32 v69, v69, v77
  v_add_f32 v70, v70, v78
  v_add_f32 v71, v71, v79
  s_waitcnt lgkmcnt(10)
  v_add_f32 v64, v64, v80
  v_add_f32 v65, v65, v81
  v_add_f32 v66, v66, v82
  v_add_f32 v67, v67, v83
  v_add_f32 v68, v68, v84
  v_add_f32 v69, v69, v85
  v_add_f32 v70, v70, v86
  v_add_f32 v71, v71, v87
  s_waitcnt lgkmcnt(8)
  v_add_f32 v64, v64, v88
  v_add_f32 v65, v65, v89
  v_add_f32 v66, v66, v90
  v_add_f32 v67, v67, v91
  v_add_f32 v68, v68, v92
  v_add_f32 v69, v69, v93
  v_add_f32 v70, v70, v94
  v_add_f32 v71, v71, v95
  s_waitcnt lgkmcnt(6)
  v_add_f32 v64, v64, v96
  v_add_f32 v65, v65, v97
  v_add_f32 v66, v66, v98
  v_add_f32 v67, v67, v99
  v_add_f32 v68, v68, v100
  v_add_f32 v69, v69, v101
  v_add_f32 v70, v70, v102
  v_add_f32 v71, v71, v103
  s_waitcnt lgkmcnt(4)
  v_add_f32 v64, v64, v104
  v_add_f32 v65, v65, v105
  v_add_f32 v66, v66, v106
  v_add_f32 v67, v67, v107
  v_add_f32 v68, v68, v108
  v_add_f32 v69, v69, v109
  v_add_f32 v70, v70, v110
  v_add_f32 v71, v71, v111
  s_waitcnt lgkmcnt(2)
  v_add_f32 v64, v64, v112
  v_add_f32 v65, v65, v113
  v_add_f32 v66, v66, v114
  v_add_f32 v67, v67, v115
  v_add_f32 v68, v68, v116
  v_add_f32 v69, v69, v117
  v_add_f32 v70, v70, v118
  v_add_f32 v71, v71, v119
  s_waitcnt lgkmcnt(0)
  v_add_f32 v64, v64, v120
  v_add_f32 v65, v65, v121
  v_add_f32 v66, v66, v122
  v_add_f32 v67, v67, v123
  v_add_f32 v68, v68, v124
  v_add_f32 v69, v69, v125
  v_add_f32 v70, v70, v126
  v_add_f32 v71, v71, v127
  v_cvt_pk_bf16_f32 v200, v64, v65
  v_cvt_pk_bf16_f32 v201, v66, v67
  v_cvt_pk_bf16_f32 v202, v68, v69
  v_cvt_pk_bf16_f32 v203, v70, v71
  buffer_store_dwordx4 v[200:203], v198, s[8:11], s27 offen
K2_END:
  s_endpgm
.section .rodata,"a"
.p2align 6
.amdhsa_kernel mha_attn_kernel
  .amdhsa_next_free_vgpr 236
  .amdhsa_next_free_sgpr 72
  .amdhsa_accum_offset 236
  .amdhsa_group_segment_fixed_size 0
  .amdhsa_kernarg_size 64
  .amdhsa_user_sgpr_count 2
  .amdhsa_user_sgpr_kernarg_segment_ptr 1
  .amdhsa_system_sgpr_workgroup_id_x 1
.end_amdhsa_kernel
.text
.section .rodata,"a"
.p2align 6
.amdhsa_kernel mha_oproj_kernel
  .amdhsa_next_free_vgpr 208
  .amdhsa_next_free_sgpr 40
  .amdhsa_accum_offset 208
  .amdhsa_group_segment_fixed_size 0
  .amdhsa_kernarg_size 64
  .amdhsa_user_sgpr_count 2
  .amdhsa_user_sgpr_kernarg_segment_ptr 1
  .amdhsa_system_sgpr_workgroup_id_x 1
.end_amdhsa_kernel
.text
```
